```python
import torch

def _softmax(x, axis=-1):
    return torch.softmax(x, dim=axis)
def _gelu(x):
    return torch.nn.functional.gelu(x, approximate="tanh")
def _silu(x):
    return torch.nn.functional.silu(x)
def _sigmoid(x):
    return torch.sigmoid(x)
def _layernorm(x, axis=-1, eps=1e-5):
    m = x.mean(dim=axis, keepdim=True)
    v = x.var(dim=axis, keepdim=True, unbiased=False)
    return (x - m) / torch.sqrt(v + eps)
def _scatter_add(tgt, idx, src, axis=0):
    return tgt.clone().index_add_(axis, idx, src)
def _segment_sum(src, seg, n):
    out = torch.zeros((n,) + src.shape[1:], dtype=src.dtype)
    return out.index_add_(0, seg, src)
def _pad(x, pw):
    flat = tuple(v for pair in reversed(pw) for v in pair)
    return torch.nn.functional.pad(x, flat)

kernel_name = 'interleave_layers__sliding_block__linear_kernel_hedgehog__prompt'

def setup_inputs():

    _w = (lambda a: (lambda t: t.to(torch.bfloat16) if t.is_floating_point() else t)(torch.as_tensor(a)))
    def _A_setup():
        B, S, D = 1, 2048, 512
        return {
            "x": _w((lambda *s: torch.randn(*s, dtype=torch.bfloat16) * 0.05)(B, S, D)),
            "wqkv": _w((lambda *s: torch.randn(*s, dtype=torch.bfloat16) * 0.05)(D, 3 * D)),
            "wo": _w((lambda *s: torch.randn(*s, dtype=torch.bfloat16) * 0.05)(D, D)),
        }
    _A_in = _A_setup()

    def _B_setup():
        B, S, D, H = 1, 2048, 512, 32
        Dh = D // H
        return {
            "x": _w((lambda *s: torch.randn(*s, dtype=torch.bfloat16) * 0.05)(B, S, D)),
            "wqkv": _w((lambda *s: torch.randn(*s, dtype=torch.bfloat16) * 0.4)(D, 3 * D)),
            "w_phi": _w((lambda *s: torch.randn(*s, dtype=torch.bfloat16) * 0.4)(H, Dh, Dh) * (Dh ** -0.5)),
            "wo": _w((lambda *s: torch.randn(*s, dtype=torch.bfloat16) * 0.05)(D, D)),
        }
    _B_in = _B_setup()

    return {
        "A_x": _A_in["x"],
        "A_wqkv": _A_in["wqkv"],
        "A_wo": _A_in["wo"],
        "B_x": _B_in["x"],
        "B_wqkv": _B_in["wqkv"],
        "B_w_phi": _B_in["w_phi"],
        "B_wo": _B_in["wo"],
    }

def reference(A_x, A_wqkv, A_wo, B_x, B_wqkv, B_w_phi, B_wo):
    def _A_ref(x, wqkv, wo):
        B, S, D = x.shape
        H = 32; Dh = D // H; W = 256
        qkv = (lambda x, *d: x.permute(*d))((x @ wqkv).reshape(B, S, 3, H, Dh), 2, 0, 3, 1, 4)
        q, k, v = qkv[0], qkv[1], qkv[2]
        scores = torch.einsum("bhqd,bhkd->bhqk", q, k) * (Dh ** -0.5)
        idx = torch.arange(S)
        mask = (idx[:, None] - idx[None, :] >= 0) & (idx[:, None] - idx[None, :] < W)
        scores = torch.where(mask[None, None], scores, -1e9)
        p = _softmax(scores, axis=-1)
        o = torch.einsum("bhqk,bhkd->bhqd", p, v)
        return (lambda x, *d: x.permute(*d))(o, 0, 2, 1, 3).reshape(B, S, D) @ wo

    def _B_ref(x, wqkv, w_phi, wo):
        B, S, D = x.shape
        H = 32; Dh = D // H
        qkv = (lambda x, *d: x.permute(*d))((x @ wqkv).reshape(B, S, 3, H, Dh), 2, 0, 3, 1, 4)
        q, k, v = qkv[0], qkv[1], qkv[2]
        pq = torch.einsum("bhsd,hdf->bhsf", q, w_phi)
        pk = torch.einsum("bhsd,hdf->bhsf", k, w_phi)
        phi_q = torch.concatenate([_softmax(pq, axis=-1), _softmax(-pq, axis=-1)], axis=-1)
        phi_k = torch.concatenate([_softmax(pk, axis=-1), _softmax(-pk, axis=-1)], axis=-1)
        kv = torch.einsum("bhsf,bhsd->bhfd", phi_k, v)
        z  = torch.einsum("bhsf->bhf", phi_k)
        num = torch.einsum("bhqf,bhfd->bhqd", phi_q, kv)
        den = torch.einsum("bhqf,bhf->bhq", phi_q, z)[..., None] + 1e-6
        o = num / den
        return (lambda x, *d: x.permute(*d))(o, 0, 2, 1, 3).reshape(B, S, D) @ wo

    x = A_x
    x = x + _A_ref(_layernorm(x, axis=-1), A_wqkv, A_wo)
    x = x + _B_ref(_layernorm(x, axis=-1), B_wqkv, B_w_phi, B_wo)
    x = x + _A_ref(_layernorm(x, axis=-1), A_wqkv, A_wo)
    x = x + _B_ref(_layernorm(x, axis=-1), B_wqkv, B_w_phi, B_wo)
    return x
```

```asm
; @launch grid=(256,1,1) block=(256,1,1) lds=163840
.amdgcn_target "amdgcn-amd-amdhsa--gfx950"
.text
.globl interleave_layers__sliding_block__linear_kernel_hedgehog__prompt_kernel
.p2align 8
.type interleave_layers__sliding_block__linear_kernel_hedgehog__prompt_kernel,@function
interleave_layers__sliding_block__linear_kernel_hedgehog__prompt_kernel:
    s_cmp_ge_u32 s2, 256
    s_cbranch_scc1 L_end
    s_load_dwordx4 s[40:43], s[0:1], 0
    s_load_dwordx2 s[46:47], s[0:1], 72
    s_load_dwordx2 s[44:45], s[0:1], 16
    s_load_dwordx4 s[48:51], s[0:1], 32
    s_load_dwordx4 s[52:55], s[0:1], 48
    v_lshrrev_b32 v1, 6, v0
    v_and_b32 v0, 63, v0
    v_readfirstlane_b32 s30, v1
    s_and_b32 s28, s2, 7
    s_lshl_b32 s28, s28, 1
    s_bfe_u32 s3, s2, 0x10003
    s_add_u32 s28, s28, s3
    s_lshr_b32 s29, s2, 4
    s_lshl_b32 s31, s28, 2
    s_add_u32 s31, s31, s30
    s_lshl_b32 s36, s31, 17
    s_lshl_b32 s60, s29, 6
    s_mov_b32 s6, 0x200000
    s_mov_b32 s7, 0x00020000
    s_mov_b32 s10, 0x180000
    s_mov_b32 s11, 0x00020000
    s_mov_b32 s18, 0x10000000
    s_mov_b32 s19, 0x00020000
    v_and_b32 v228, 3, v0
    v_lshrrev_b32 v232, 2, v0
    v_lshlrev_b32 v233, 4, v228
    v_add_u32 v233, s60, v233
    v_mul_u32_u24 v230, 3072, v232
    v_add_u32 v230, v230, v233
    v_lshl_add_u32 v5, v232, 10, v233
    s_bfe_u32 s68, s2, 0x20003
    s_lshl_b32 s69, s30, 13
    s_mul_i32 s39, s30, 393216
    s_lshr_b32 s70, s2, 3
    s_lshl_b32 s70, s70, 2
    s_add_u32 s70, s70, s30
    v_lshlrev_b32 v234, 7, v0
    s_lshl_b32 s61, s29, 11
    v_add_u32 v232, s61, v234
    s_lshl_b32 s61, s29, 8
    s_add_u32 s61, s61, 65536
    v_writelane_b32 v232, s61, 16
    s_add_u32 s61, s61, 128
    v_writelane_b32 v232, s61, 17
    s_and_b32 s61, s29, 3
    s_lshl_b32 s61, s61, 7
    s_and_b32 s62, s29, 4
    s_lshl_b32 s62, s62, 8
    s_add_u32 s61, s61, s62
    s_add_u32 s61, s61, 73728
    v_writelane_b32 v232, s61, 18
    s_lshl_b32 s61, s70, 8
    v_add_u32 v233, s61, v234
    s_getpc_b64 s[62:63]
    s_lshl_b32 s60, s30, 12
    s_add_u32 m0, s60, 98304
    s_lshl_b32 s61, s31, 15
    s_add_u32 s71, s61, 15360
    v_lshlrev_b32 v1, 4, v0
    s_lshl_b32 s3, s29, 10
    s_and_b32 s26, s29, 1
    s_lshr_b32 s27, s30, 1
    s_lshl_b32 s64, s28, 1
    s_add_u32 s64, s64, s26
    s_lshl_b32 s64, s64, 1
    s_and_b32 s65, s30, 1
    s_add_u32 s64, s64, s65
    s_sub_u32 s65, s27, s26
    s_lshl_b32 s26, s65, 6
    s_lshl_b32 s27, s64, 15
    s_add_u32 s26, s26, s27
    v_add_u32 v222, s26, v5
    v_add_u32 v223, s3, v1
    v_lshlrev_b32 v231, 10, v0
    s_mul_i32 s24, s70, 12288
    s_and_b32 s25, s2, 7
    s_lshl_b32 s25, s25, 7
    s_add_u32 s25, s25, s70
    s_lshl_b32 s25, s25, 11
    s_waitcnt lgkmcnt(0)
    s_mov_b32 s4, s40
    s_mov_b32 s5, s41
    s_mov_b64 exec, 3
    buffer_load_dword v160, v231, s[4:7], s25 offen offset:384
    s_mov_b32 s8, s42
    s_mov_b32 s9, s43
    s_mov_b64 exec, 0xfff
    buffer_load_dword v161, v231, s[8:11], s24 offen offset:384
    s_mov_b64 exec, -1
    s_mov_b32 s8, s42
    s_mov_b32 s9, s43
    s_mov_b32 s16, s46
    s_mov_b32 s17, s47
    s_mov_b64 exec, 3
    global_load_dword v166, v233, s[62:63]
    s_mov_b64 exec, -1
    s_add_u32 m0, s60, 98304
    s_nop 0
    buffer_load_dwordx4 v5, s[4:7], s61 offen lds
    buffer_load_dwordx4 v5, s[4:7], s71 offen offset:1024 lds
    s_mov_b32 s4, s50
    s_mov_b32 s5, s51
    s_mov_b32 s6, 0x4000
    s_add_u32 m0, s60, 100352
    s_nop 0
    buffer_load_dwordx4 v223, s[4:7], 0 offen lds
    s_mov_b64 exec, 458752
    buffer_load_dword v162, v232, s[16:19], s36 offen
    s_mov_b64 exec, -1
    s_add_u32 s67, s68, 0
    s_and_b32 s67, s67, 3
    s_lshl_b32 s66, s67, 11
    s_add_u32 s66, s66, s69
    s_add_u32 m0, s66, 32768
    s_mul_i32 s67, s67, 98304
    s_add_u32 s67, s67, s39
    s_add_u32 s67, s67, 1024
    buffer_load_dwordx4 v230, s[8:11], s67 offen lds
    s_add_u32 s67, s67, 48128
    buffer_load_dwordx4 v230, s[8:11], s67 offen offset:1024 lds
    s_add_u32 s66, s46, 18350080
    s_addc_u32 s67, s47, 0
    s_load_dword s32, s[66:67], 0
    s_add_u32 s67, s68, 0
    s_and_b32 s67, s67, 3
    s_lshl_b32 s66, s67, 11
    s_add_u32 s66, s66, s69
    s_add_u32 m0, s66, 65536
    s_mul_i32 s67, s67, 98304
    s_add_u32 s67, s67, s39
    s_add_u32 s67, s67, 2048
    buffer_load_dwordx4 v230, s[8:11], s67 offen lds
    s_add_u32 s67, s67, 48128
    buffer_load_dwordx4 v230, s[8:11], s67 offen offset:1024 lds
    s_lshr_b32 s61, s60, 1
    s_mov_b32 s20, s40
    s_mov_b32 s21, s41
    s_mov_b32 s22, 0x200000
    s_mov_b32 s23, 0x00020000
    s_mov_b32 s4, s48
    s_mov_b32 s5, s49
    s_mov_b32 s6, 0x180000
    s_mov_b32 s12, s50
    s_mov_b32 s13, s51
    s_mov_b32 s14, 0x4000
    s_mov_b32 s15, 0x00020000
    s_mov_b32 s0, s54
    s_mov_b32 s1, s55
    s_lshl_b32 s55, s29, 11
    v_and_b32 v224, 31, v0
    v_lshrrev_b32 v225, 5, v0
    s_add_u32 s60, s60, 98304
    v_add_u32 v100, s60, v1
    v_lshlrev_b32 v231, 6, v224
    v_lshl_add_u32 v231, v225, 3, v231
    s_add_u32 s61, s61, 115072
    v_add_u32 v235, s61, v231
    v_add_u32 v231, s60, v231
    v_lshlrev_b32 v232, 4, v224
    v_add_u32 v232, 65536, v232
    v_lshl_add_u32 v6, v225, 11, v232
    v_lshl_add_u32 v7, v225, 2, v232
    s_lshr_b32 s62, s29, 1
    s_lshl_b32 s62, s62, 9
    s_and_b32 s63, s29, 1
    s_lshl_b32 s63, s63, 3
    s_add_u32 s62, s62, s63
    v_add_u32 v7, s62, v7
    v_mov_b32 v111, 0
    s_getreg_b32 s35, hwreg(HW_REG_XCC_ID, 0, 4)
    v_bfe_u32 v227, v0, 2, 2
    v_bfe_u32 v229, v0, 4, 1
    v_lshlrev_b32 v234, 5, v227
    v_lshl_add_u32 v234, v228, 3, v234
    v_lshl_add_u32 v234, v225, 7, v234
    v_add_u32 v234, s60, v234
    v_lshlrev_b32 v232, 6, v227
    v_lshl_add_u32 v232, v229, 5, v232
    v_lshl_add_u32 v232, v228, 3, v232
    v_lshl_add_u32 v4, v225, 8, v232
    v_add_u32 v4, 131072, v4
    v_add_u32 v12, s69, v1
    v_lshrrev_b32 v232, 1, v227
    v_xor_b32 v232, v232, v227
    s_lshr_b32 s62, s30, 1
    v_xor_b32 v232, s62, v232
    v_and_b32 v232, 1, v232
    v_lshlrev_b32 v232, 6, v232
    v_lshl_add_u32 v232, v227, 7, v232
    v_lshl_add_u32 v232, v225, 9, v232
    v_lshl_add_u32 v232, v229, 5, v232
    v_lshl_add_u32 v232, v228, 3, v232
    s_lshl_b32 s63, s62, 14
    s_add_u32 s63, s63, 131072
    v_add_u32 v98, s63, v232
    v_xor_b32 v109, 64, v98
    v_lshrrev_b32 v232, 3, v0
    v_lshrrev_b32 v233, 4, v0
    v_xor_b32 v233, v232, v233
    v_and_b32 v233, 1, v233
    v_lshlrev_b32 v233, 6, v233
    v_and_b32 v5, 0x70, v1
    v_xor_b32 v5, v233, v5
    v_lshl_add_u32 v5, v232, 10, v5
    s_lshl_b32 s62, s62, 18
    s_and_b32 s63, s30, 1
    s_lshl_b32 s63, s63, 16
    s_add_u32 s62, s62, s63
    s_lshr_b32 s63, s29, 1
    s_lshl_b32 s63, s63, 7
    s_add_u32 s62, s62, s63
    v_add_u32 v5, s62, v5
    s_add_u32 s57, s29, s65
    s_lshl_b32 s57, s57, 11
    s_lshl_b32 s62, s64, 17
    s_add_u32 s57, s57, s62
    v_add_u32 v13, 0x10000, v12
    s_lshl_b32 s63, s30, 13
    s_sub_u32 s63, s63, 131072
    v_add_u32 v220, s63, v4
    v_add_u32 v221, 0x10000, v220
    v_lshrrev_b32 v216, 4, v0
    v_xor_b32 v216, v216, v0
    v_and_b32 v216, 1, v216
    v_add_u32 v216, -1, v216
    v_and_b32 v216, 0x3f803f80, v216
    v_mov_b32 v217, v216
    v_mov_b32 v218, v216
    v_mov_b32 v219, v216
    s_mov_b32 s62, s68
    s_lshl_b32 s63, s62, 11
    v_add_u32 v176, s63, v220
    v_add_u32 v180, s63, v12
    v_add_u32 v248, s63, v221
    v_add_u32 v252, s63, v13
    s_add_u32 s62, s62, 1
    s_and_b32 s62, s62, 3
    s_lshl_b32 s63, s62, 11
    v_add_u32 v177, s63, v220
    v_add_u32 v181, s63, v12
    v_add_u32 v249, s63, v221
    v_add_u32 v253, s63, v13
    s_add_u32 s62, s62, 1
    s_and_b32 s62, s62, 3
    s_lshl_b32 s63, s62, 11
    v_add_u32 v178, s63, v220
    v_add_u32 v182, s63, v12
    v_add_u32 v250, s63, v221
    v_add_u32 v254, s63, v13
    s_add_u32 s62, s62, 1
    s_and_b32 s62, s62, 3
    s_lshl_b32 s63, s62, 11
    v_add_u32 v179, s63, v220
    v_add_u32 v183, s63, v12
    v_add_u32 v251, s63, v221
    v_add_u32 v255, s63, v13
    v_and_b32 v226, 15, v0
    v_lshlrev_b32 v110, 2, v226
    v_lshlrev_b32 v97, 3, v0
    s_lshl_b32 s60, s29, 2
    s_add_u32 s60, s60, s30
    s_lshl_b32 s60, s60, 4
    s_lshl_b32 s50, s60, 9
    s_add_u32 s50, s50, 18874368
    s_lshr_b32 s60, s60, 5
    s_lshl_b32 s51, s60, 11
    s_and_b32 s60, s30, 1
    s_lshl_b32 s60, s60, 6
    s_add_u32 s51, s51, s60
    s_add_u32 s51, s51, 18087936
    s_lshl_b32 s60, s28, 9
    s_add_u32 s48, s50, s60
    s_lshl_b32 s60, s28, 7
    s_add_u32 s49, s51, s60
    s_mov_b32 s33, 0
    s_mov_b32 s24, s36
    s_mov_b32 s58, 0x0000ffff
    s_mov_b32 s59, 0x0000ffff
    s_mov_b32 s56, 1.0
    s_mov_b32 s37, 0x3eb8aa3b
    s_lshl_b32 s27, s28, 2
    s_lshl_b32 s60, s30, 1
    s_add_u32 s27, s27, s60
    s_sub_u32 s27, s27, 8
    s_lshl_b32 s60, s29, 12
    s_add_u32 s60, s60, 8388608
    s_lshl_b32 s40, s31, 17
    s_add_u32 s40, s40, s60
    s_lshl_b32 s42, s27, 17
    s_add_u32 s42, s42, s60
    s_lshl_b32 s60, s29, 9
    s_add_u32 s61, s60, 16777216
    s_lshl_b32 s41, s31, 14
    s_add_u32 s41, s41, s61
    s_lshl_b32 s43, s27, 14
    s_add_u32 s43, s43, s61
    s_lshl_b32 s60, s29, 7
    s_lshl_b32 s54, s30, 11
    s_add_u32 s54, s54, s60
    s_add_u32 s54, s54, 17825792
    v_add_u32 v2, 0x10000, v1
    s_lshl_b32 s60, s30, 10
    s_add_u32 s60, s60, 123904
    v_lshlrev_b32 v8, 4, v225
    v_add_u32 v8, s60, v8
    v_lshlrev_b32 v3, 2, v224
    v_add_u32 v9, s60, v3
    s_lshl_b32 s60, s30, 8
    s_add_u32 s60, s60, 128000
    v_add_u32 v10, s60, v3
    v_lshlrev_b32 v11, 4, v225
    v_add_u32 v11, s60, v11
    s_lshl_b32 s60, s30, 11
    s_add_u32 s60, s60, 115072
    v_add_u32 v101, s60, v1
    s_lshl_b32 s60, s30, 2
    s_add_u32 s60, s60, 123264
    v_mov_b32 v102, s60
    s_lshr_b32 s26, s30, 1
    s_and_b32 s71, s30, 1
    s_mul_i32 s62, s71, 4128
    s_lshl_b32 s63, s26, 10
    s_add_u32 s60, s62, s63
    s_add_u32 s60, s60, 65536
    v_add_u32 v103, s60, v1
    s_sub_u32 s60, s63, s62
    s_add_u32 s60, s60, 77920
    v_add_u32 v104, s60, v1
    s_lshl_b32 s61, s26, 8
    v_add_u32 v105, s61, v1
    v_mov_b32 v106, 1024
    v_cndmask_b32_e64 v105, v106, v105, s[58:59]
    s_sub_u32 s60, 79968, s62
    v_add_u32 v106, s60, v105
    s_add_u32 s60, s62, 67584
    v_add_u32 v105, s60, v105
    s_lshl_b32 s62, s71, 11
    s_add_u32 s60, s63, s62
    s_add_u32 s60, s60, 115072
    v_add_u32 v107, s60, v1
    s_sub_u32 s60, s63, s62
    s_add_u32 s60, s60, 121216
    v_add_u32 v108, s60, v1
    s_add_u32 s63, s63, s55
    s_add_u32 s63, s63, 32768
    s_lshl_b32 s61, s28, 2
    s_add_u32 s62, s61, s71
    s_add_u32 s61, s61, 3
    s_sub_u32 s61, s61, s71
    s_lshl_b32 s38, s62, 17
    s_add_u32 s46, s38, s63
    s_lshl_b32 s25, s61, 17
    s_add_u32 s47, s25, s63
    s_lshl_b32 s63, s29, 1
    s_add_u32 s63, s63, s26
    s_lshl_b32 s63, s63, 2
    s_add_u32 s63, s63, 74752
    s_add_u32 s38, s38, s63
    s_add_u32 s25, s25, s63
    s_cmp_lt_i32 s27, 0
    s_cselect_b32 s42, s36, s42
    s_cselect_b32 s43, s36, s43
    v_lshlrev_b32 v232, 2, v225
    v_sub_u32 v232, v224, v232
    v_mov_b32 v233, 0xf149f2ca
    v_cmp_le_i32 vcc, 0, v232
    v_mov_b32 v80, 0x3f803f80
    s_nop 0
    v_cndmask_b32_e64 v32, v233, 0, vcc
    v_cndmask_b32_e64 v48, 0, v233, vcc
    v_cmp_le_i32 vcc, 1, v232
    v_mov_b32 v81, 0x3f803f80
    s_nop 0
    v_cndmask_b32_e64 v33, v233, 0, vcc
    v_cndmask_b32_e64 v49, 0, v233, vcc
    v_cmp_le_i32 vcc, 2, v232
    v_mov_b32 v82, 0x3f803f80
    s_nop 0
    v_cndmask_b32_e64 v34, v233, 0, vcc
    v_cndmask_b32_e64 v50, 0, v233, vcc
    v_cmp_le_i32 vcc, 3, v232
    v_mov_b32 v83, 0x3f803f80
    s_nop 0
    v_cndmask_b32_e64 v35, v233, 0, vcc
    v_cndmask_b32_e64 v51, 0, v233, vcc
    v_cmp_le_i32 vcc, 8, v232
    v_mov_b32 v84, 0x3f803f80
    s_nop 0
    v_cndmask_b32_e64 v36, v233, 0, vcc
    v_cndmask_b32_e64 v52, 0, v233, vcc
    v_cmp_le_i32 vcc, 9, v232
    v_mov_b32 v85, 0x3f803f80
    s_nop 0
    v_cndmask_b32_e64 v37, v233, 0, vcc
    v_cndmask_b32_e64 v53, 0, v233, vcc
    v_cmp_le_i32 vcc, 10, v232
    v_mov_b32 v86, 0x3f803f80
    s_nop 0
    v_cndmask_b32_e64 v38, v233, 0, vcc
    v_cndmask_b32_e64 v54, 0, v233, vcc
    v_cmp_le_i32 vcc, 11, v232
    v_mov_b32 v87, 0x3f803f80
    s_nop 0
    v_cndmask_b32_e64 v39, v233, 0, vcc
    v_cndmask_b32_e64 v55, 0, v233, vcc
    v_cmp_le_i32 vcc, 16, v232
    v_mov_b32 v88, 0x3f803f80
    s_nop 0
    v_cndmask_b32_e64 v40, v233, 0, vcc
    v_cndmask_b32_e64 v56, 0, v233, vcc
    v_cmp_le_i32 vcc, 17, v232
    v_mov_b32 v89, 0x3f803f80
    s_nop 0
    v_cndmask_b32_e64 v41, v233, 0, vcc
    v_cndmask_b32_e64 v57, 0, v233, vcc
    v_cmp_le_i32 vcc, 18, v232
    v_mov_b32 v90, 0x3f803f80
    s_nop 0
    v_cndmask_b32_e64 v42, v233, 0, vcc
    v_cndmask_b32_e64 v58, 0, v233, vcc
    v_cmp_le_i32 vcc, 19, v232
    v_mov_b32 v91, 0x3f803f80
    s_nop 0
    v_cndmask_b32_e64 v43, v233, 0, vcc
    v_cndmask_b32_e64 v59, 0, v233, vcc
    v_cmp_le_i32 vcc, 24, v232
    v_mov_b32 v92, 0x3f803f80
    s_nop 0
    v_cndmask_b32_e64 v44, v233, 0, vcc
    v_cndmask_b32_e64 v60, 0, v233, vcc
    v_cmp_le_i32 vcc, 25, v232
    v_mov_b32 v93, 0x3f803f80
    s_nop 0
    v_cndmask_b32_e64 v45, v233, 0, vcc
    v_cndmask_b32_e64 v61, 0, v233, vcc
    v_cmp_le_i32 vcc, 26, v232
    v_mov_b32 v94, 0x3f803f80
    s_nop 0
    v_cndmask_b32_e64 v46, v233, 0, vcc
    v_cndmask_b32_e64 v62, 0, v233, vcc
    v_cmp_le_i32 vcc, 27, v232
    v_mov_b32 v95, 0x3f803f80
    s_nop 0
    v_cndmask_b32_e64 v47, v233, 0, vcc
    v_cndmask_b32_e64 v63, 0, v233, vcc
    v_mov_b32 v227, 0x3f80
    v_mov_b32 v228, 0x3f800000
    v_cmp_eq_u32 vcc, 0, v224
    v_cmp_eq_u32 s[60:61], 1, v224
    s_nop 0
    v_cndmask_b32_e64 v72, 0, v227, vcc
    v_cndmask_b32_e64 v72, v72, v228, s[60:61]
    v_cmp_eq_u32 vcc, 2, v224
    v_cmp_eq_u32 s[60:61], 3, v224
    s_nop 0
    v_cndmask_b32_e64 v73, 0, v227, vcc
    v_cndmask_b32_e64 v73, v73, v228, s[60:61]
    v_cmp_eq_u32 vcc, 4, v224
    v_cmp_eq_u32 s[60:61], 5, v224
    s_nop 0
    v_cndmask_b32_e64 v74, 0, v227, vcc
    v_cndmask_b32_e64 v74, v74, v228, s[60:61]
    v_cmp_eq_u32 vcc, 6, v224
    v_cmp_eq_u32 s[60:61], 7, v224
    s_nop 0
    v_cndmask_b32_e64 v75, 0, v227, vcc
    v_cndmask_b32_e64 v75, v75, v228, s[60:61]
    v_bfe_u32 v232, v0, 2, 3
    v_lshl_add_u32 v232, v225, 4, v232
    v_and_b32 v233, 1, v0
    v_lshl_add_u32 v232, v233, 5, v232
    v_and_b32 v233, 2, v0
    v_lshlrev_b32 v233, 2, v233
    v_lshl_add_u32 v232, v232, 4, v233
    s_lshl_b32 s60, s30, 10
    s_add_u32 s60, s60, 98304
    v_add_u32 v76, s60, v232
    v_lshrrev_b32 v232, 4, v0
    v_lshlrev_b32 v232, 9, v232
    v_lshl_add_u32 v232, v226, 4, v232
    s_lshr_b32 s60, s30, 1
    s_lshl_b32 s60, s60, 8
    s_add_u32 s60, s60, 115072
    v_add_u32 v77, s60, v232
    v_lshl_add_u32 v232, v226, 1, v225
    v_lshlrev_b32 v232, 4, v232
    v_bfe_u32 v233, v0, 4, 1
    v_lshl_add_u32 v232, v233, 3, v232
    s_mul_i32 s60, s30, 544
    s_add_u32 s60, s60, 128896
    v_add_u32 v78, s60, v232
    v_bfe_u32 v232, v0, 2, 1
    v_lshlrev_b32 v232, 4, v232
    v_and_b32 v233, 3, v0
    v_lshl_add_u32 v232, v233, 1, v232
    v_and_b32 v233, 8, v0
    s_add_u32 s60, s60, 512
    v_add3_u32 v79, v232, v233, s60
    s_add_u32 s67, s68, 0
    s_and_b32 s67, s67, 3
    s_lshl_b32 s66, s67, 11
    s_add_u32 s66, s66, s69
    s_add_u32 m0, s66, 0
    s_mul_i32 s67, s67, 98304
    s_add_u32 s67, s67, s39
    s_add_u32 s67, s67, 0
    buffer_load_dwordx4 v230, s[8:11], s67 offen lds
    s_add_u32 s67, s67, 48128
    buffer_load_dwordx4 v230, s[8:11], s67 offen offset:1024 lds
    s_waitcnt vmcnt(8)
    ds_read_b64 v[240:241], v231 offset:0
    ds_read_b64 v[242:243], v231 offset:16
    ds_read_b64 v[244:245], v231 offset:32
    ds_read_b64 v[246:247], v231 offset:48
    s_add_u32 s3, s55, s36
    s_waitcnt lgkmcnt(0)
    buffer_store_dwordx4 v[240:243], v1, s[16:19], s3 offen
    buffer_store_dwordx4 v[244:247], v1, s[16:19], s3 offen offset:1024
    v_lshlrev_b32 v16, 16, v240
    v_and_b32 v17, 0xffff0000, v240
    v_lshlrev_b32 v18, 16, v241
    v_and_b32 v19, 0xffff0000, v241
    v_lshlrev_b32 v20, 16, v242
    v_and_b32 v21, 0xffff0000, v242
    v_lshlrev_b32 v22, 16, v243
    v_and_b32 v23, 0xffff0000, v243
    v_lshlrev_b32 v24, 16, v244
    v_and_b32 v25, 0xffff0000, v244
    v_lshlrev_b32 v26, 16, v245
    v_and_b32 v27, 0xffff0000, v245
    v_lshlrev_b32 v28, 16, v246
    v_and_b32 v29, 0xffff0000, v246
    v_lshlrev_b32 v30, 16, v247
    v_and_b32 v31, 0xffff0000, v247
    v_pk_add_f32 v[236:237], v[16:17], v[18:19]
    v_pk_mul_f32 v[238:239], v[16:17], v[16:17]
    v_pk_fma_f32 v[238:239], v[18:19], v[18:19], v[238:239]
    v_pk_add_f32 v[236:237], v[236:237], v[20:21]
    v_pk_fma_f32 v[238:239], v[20:21], v[20:21], v[238:239]
    v_pk_add_f32 v[236:237], v[236:237], v[22:23]
    v_pk_fma_f32 v[238:239], v[22:23], v[22:23], v[238:239]
    v_pk_add_f32 v[236:237], v[236:237], v[24:25]
    v_pk_fma_f32 v[238:239], v[24:25], v[24:25], v[238:239]
    v_pk_add_f32 v[236:237], v[236:237], v[26:27]
    v_pk_fma_f32 v[238:239], v[26:27], v[26:27], v[238:239]
    v_pk_add_f32 v[236:237], v[236:237], v[28:29]
    v_pk_fma_f32 v[238:239], v[28:29], v[28:29], v[238:239]
    v_pk_add_f32 v[236:237], v[236:237], v[30:31]
    v_pk_fma_f32 v[238:239], v[30:31], v[30:31], v[238:239]
    v_add_f32 v236, v236, v237
    v_add_f32 v238, v238, v239
    s_nop 1
    v_permlane32_swap_b32 v236, v238
    v_add_f32 v236, v236, v238
    v_and_or_b32 v236, v236, -16, 1
    buffer_store_dword v236, v7, s[16:19], s36 offen
    s_waitcnt lgkmcnt(0)
    s_lshr_b32 s32, s32, 4
    s_mul_i32 s32, s32, 0x9E3779B1
    s_add_u32 s32, s32, 0x1234567
    s_lshl_b32 s32, s32, 4
    s_or_b32 s65, s32, s35
    v_mov_b32 v237, s65
    s_lshl_b32 s3, s29, 2
    s_add_u32 s3, s3, s36
    s_add_u32 s3, s3, 73728
    v_mov_b32 v96, s32
    v_mul_u32_u24 v229, 0x8000, v229
    v_lshl_or_b32 v229, v229, 16, v229
    s_add_u32 s67, s68, 1
    s_and_b32 s67, s67, 3
    s_lshl_b32 s66, s67, 11
    s_add_u32 s66, s66, s69
    s_add_u32 m0, s66, 32768
    s_mul_i32 s67, s67, 98304
    s_add_u32 s67, s67, s39
    s_add_u32 s67, s67, 1024
    buffer_load_dwordx4 v230, s[8:11], s67 offen lds
    s_add_u32 s67, s67, 48128
    buffer_load_dwordx4 v230, s[8:11], s67 offen offset:1024 lds
    s_add_u32 s67, s68, 2
    s_and_b32 s67, s67, 3
    s_lshl_b32 s66, s67, 11
    s_add_u32 s66, s66, s69
    s_add_u32 m0, s66, 32768
    s_mul_i32 s67, s67, 98304
    s_add_u32 s67, s67, s39
    s_add_u32 s67, s67, 1024
    buffer_load_dwordx4 v230, s[8:11], s67 offen lds
    s_add_u32 s67, s67, 48128
    buffer_load_dwordx4 v230, s[8:11], s67 offen offset:1024 lds
    s_add_u32 s67, s68, 3
    s_and_b32 s67, s67, 3
    s_lshl_b32 s66, s67, 11
    s_add_u32 s66, s66, s69
    s_add_u32 m0, s66, 32768
    s_mul_i32 s67, s67, 98304
    s_add_u32 s67, s67, s39
    s_add_u32 s67, s67, 1024
    buffer_load_dwordx4 v230, s[8:11], s67 offen lds
    s_waitcnt vmcnt(13)
    ds_read_b64_tr_b16 v[184:185], v176 offset:32768
    ds_read_b64_tr_b16 v[186:187], v176 offset:33280
    s_add_u32 s67, s67, 48128
    buffer_load_dwordx4 v230, s[8:11], s67 offen offset:1024 lds
    s_lshl_b32 s66, s30, 11
    s_add_u32 m0, s66, 115072
    s_nop 0
    buffer_load_dwordx4 v222, s[20:23], 0 offen lds
    s_mov_b32 s66, 15360
    buffer_load_dwordx4 v222, s[20:23], s66 offen offset:1024 lds
    s_mov_b32 s12, s44
    s_mov_b32 s13, s45
    s_mov_b32 s14, 0x80000
    s_mov_b32 s20, s0
    s_mov_b32 s21, s1
    s_waitcnt vmcnt(15)
    ds_read_b64_tr_b16 v[188:189], v176 offset:33792
    ds_read_b64_tr_b16 v[190:191], v176 offset:34304
    s_add_u32 s67, s68, 1
    s_and_b32 s67, s67, 3
    s_lshl_b32 s66, s67, 11
    s_add_u32 s66, s66, s69
    s_add_u32 m0, s66, 65536
    s_mul_i32 s67, s67, 98304
    s_add_u32 s67, s67, s39
    s_add_u32 s67, s67, 2048
    buffer_load_dwordx4 v230, s[8:11], s67 offen lds
    s_waitcnt vmcnt(15)
    ds_read_b64_tr_b16 v[192:193], v248 offset:0
    ds_read_b64_tr_b16 v[194:195], v248 offset:512
    s_waitcnt lgkmcnt(4)
    v_mfma_f32_16x16x32_bf16 v[112:115], v[216:219], v[184:187], 0
    ds_write_b128 v180, v[184:187] offset:32768
    s_add_u32 s67, s67, 48128
    buffer_load_dwordx4 v230, s[8:11], s67 offen offset:1024 lds
    s_waitcnt vmcnt(15)
    ds_read_b64_tr_b16 v[196:197], v248 offset:1024
    ds_read_b64_tr_b16 v[198:199], v248 offset:1536
    s_waitcnt lgkmcnt(5)
    v_mfma_f32_16x16x32_bf16 v[112:115], v[216:219], v[188:191], v[112:115]
    ds_write_b128 v180, v[188:191] offset:33792
    s_add_u32 s67, s68, 2
    s_and_b32 s67, s67, 3
    s_lshl_b32 s66, s67, 11
    s_add_u32 s66, s66, s69
    s_add_u32 m0, s66, 65536
    s_mul_i32 s67, s67, 98304
    s_add_u32 s67, s67, s39
    s_add_u32 s67, s67, 2048
    buffer_load_dwordx4 v230, s[8:11], s67 offen lds
    s_waitcnt vmcnt(15)
    ds_read_b64_tr_b16 v[200:201], v176 offset:0
    ds_read_b64_tr_b16 v[202:203], v176 offset:512
    s_waitcnt lgkmcnt(6)
    v_mfma_f32_16x16x32_bf16 v[128:131], v[216:219], v[192:195], 0
    ds_write_b128 v252, v[192:195] offset:0
    s_add_u32 s67, s67, 48128
    buffer_load_dwordx4 v230, s[8:11], s67 offen offset:1024 lds
    s_waitcnt vmcnt(15)
    ds_read_b64_tr_b16 v[204:205], v176 offset:1024
    ds_read_b64_tr_b16 v[206:207], v176 offset:1536
    s_waitcnt lgkmcnt(6)
    v_mfma_f32_16x16x32_bf16 v[128:131], v[216:219], v[196:199], v[128:131]
    ds_write_b128 v252, v[196:199] offset:1024
    s_add_u32 s67, s68, 3
    s_and_b32 s67, s67, 3
    s_lshl_b32 s66, s67, 11
    s_add_u32 s66, s66, s69
    s_add_u32 m0, s66, 65536
    s_mul_i32 s67, s67, 98304
    s_add_u32 s67, s67, s39
    s_add_u32 s67, s67, 2048
    buffer_load_dwordx4 v230, s[8:11], s67 offen lds
    s_waitcnt vmcnt(12)
    ds_read_b64_tr_b16 v[208:209], v177 offset:32768
    ds_read_b64_tr_b16 v[210:211], v177 offset:33280
    s_mov_b64 exec, 1
    buffer_store_dword v237, v111, s[16:19], s3 offen
    s_mov_b64 exec, -1
    s_waitcnt lgkmcnt(6)
    v_mfma_f32_16x16x32_bf16 v[144:147], v[216:219], v[200:203], 0
    ds_write_b128 v180, v[200:203] offset:0
    s_add_u32 s67, s67, 48128
    buffer_load_dwordx4 v230, s[8:11], s67 offen offset:1024 lds
    s_waitcnt vmcnt(13)
    ds_read_b64_tr_b16 v[212:213], v177 offset:33792
    ds_read_b64_tr_b16 v[214:215], v177 offset:34304
    s_waitcnt lgkmcnt(6)
    v_mfma_f32_16x16x32_bf16 v[144:147], v[216:219], v[204:207], v[144:147]
    ds_write_b128 v180, v[204:207] offset:1024
    s_add_u32 s67, s68, 1
    s_and_b32 s67, s67, 3
    s_lshl_b32 s66, s67, 11
    s_add_u32 s66, s66, s69
    s_add_u32 m0, s66, 0
    s_mul_i32 s67, s67, 98304
    s_add_u32 s67, s67, s39
    s_add_u32 s67, s67, 0
    buffer_load_dwordx4 v230, s[8:11], s67 offen lds
    s_waitcnt vmcnt(13)
    ds_read_b64_tr_b16 v[184:185], v178 offset:32768
    ds_read_b64_tr_b16 v[186:187], v178 offset:33280
    s_waitcnt lgkmcnt(6)
    v_mfma_f32_16x16x32_bf16 v[112:115], v[216:219], v[208:211], v[112:115]
    ds_write_b128 v181, v[208:211] offset:32768
    s_add_u32 s67, s67, 48128
    buffer_load_dwordx4 v230, s[8:11], s67 offen offset:1024 lds
    s_waitcnt vmcnt(13)
    ds_read_b64_tr_b16 v[188:189], v178 offset:33792
    ds_read_b64_tr_b16 v[190:191], v178 offset:34304
    s_waitcnt lgkmcnt(6)
    v_mfma_f32_16x16x32_bf16 v[112:115], v[216:219], v[212:215], v[112:115]
    ds_write_b128 v181, v[212:215] offset:33792
    s_add_u32 s67, s68, 2
    s_and_b32 s67, s67, 3
    s_lshl_b32 s66, s67, 11
    s_add_u32 s66, s66, s69
    s_add_u32 m0, s66, 0
    s_mul_i32 s67, s67, 98304
    s_add_u32 s67, s67, s39
    s_add_u32 s67, s67, 0
    buffer_load_dwordx4 v230, s[8:11], s67 offen lds
    s_waitcnt vmcnt(13)
    ds_read_b64_tr_b16 v[192:193], v179 offset:32768
    ds_read_b64_tr_b16 v[194:195], v179 offset:33280
    s_waitcnt lgkmcnt(6)
    v_mfma_f32_16x16x32_bf16 v[112:115], v[216:219], v[184:187], v[112:115]
    ds_write_b128 v182, v[184:187] offset:32768
    s_add_u32 s67, s67, 48128
    buffer_load_dwordx4 v230, s[8:11], s67 offen offset:1024 lds
    s_waitcnt vmcnt(13)
    ds_read_b64_tr_b16 v[196:197], v179 offset:33792
    ds_read_b64_tr_b16 v[198:199], v179 offset:34304
    s_waitcnt lgkmcnt(6)
    v_mfma_f32_16x16x32_bf16 v[112:115], v[216:219], v[188:191], v[112:115]
    ds_write_b128 v182, v[188:191] offset:33792
    s_add_u32 s67, s68, 3
    s_and_b32 s67, s67, 3
    s_lshl_b32 s66, s67, 11
    s_add_u32 s66, s66, s69
    s_add_u32 m0, s66, 0
    s_mul_i32 s67, s67, 98304
    s_add_u32 s67, s67, s39
    s_add_u32 s67, s67, 0
    buffer_load_dwordx4 v230, s[8:11], s67 offen lds
    s_waitcnt vmcnt(12)
    ds_read_b64_tr_b16 v[64:65], v234 offset:2048
    ds_read_b64_tr_b16 v[66:67], v234 offset:2304
    ds_read_b64_tr_b16 v[68:69], v234 offset:2560
    ds_read_b64_tr_b16 v[70:71], v234 offset:2816
    ds_read_b64 v[168:169], v235 offset:0
    ds_read_b64 v[170:171], v235 offset:16
    ds_read_b64 v[172:173], v235 offset:32
    ds_read_b64 v[174:175], v235 offset:48
    s_waitcnt vmcnt(11)
    ds_read_b64_tr_b16 v[200:201], v249 offset:0
    ds_read_b64_tr_b16 v[202:203], v249 offset:512
    s_waitcnt lgkmcnt(14)
    v_mfma_f32_16x16x32_bf16 v[112:115], v[216:219], v[192:195], v[112:115]
    ds_write_b128 v183, v[192:195] offset:32768
    s_add_u32 s67, s67, 48128
    buffer_load_dwordx4 v230, s[8:11], s67 offen offset:1024 lds
    s_waitcnt lgkmcnt(10)
    v_xor_b32 v64, v229, v64
    s_waitcnt lgkmcnt(6)
    v_lshlrev_b32 v16, 16, v168
    v_and_b32 v17, 0xffff0000, v168
    v_xor_b32 v65, v229, v65
    v_lshlrev_b32 v18, 16, v169
    v_and_b32 v19, 0xffff0000, v169
    v_xor_b32 v66, v229, v66
    s_waitcnt lgkmcnt(5)
    v_lshlrev_b32 v20, 16, v170
    v_and_b32 v21, 0xffff0000, v170
    v_xor_b32 v67, v229, v67
    v_lshlrev_b32 v22, 16, v171
    v_and_b32 v23, 0xffff0000, v171
    v_xor_b32 v68, v229, v68
    s_waitcnt lgkmcnt(4)
    v_lshlrev_b32 v24, 16, v172
    v_and_b32 v25, 0xffff0000, v172
    v_xor_b32 v69, v229, v69
    v_lshlrev_b32 v26, 16, v173
    v_and_b32 v27, 0xffff0000, v173
    v_xor_b32 v70, v229, v70
    s_waitcnt lgkmcnt(3)
    v_lshlrev_b32 v28, 16, v174
    v_and_b32 v29, 0xffff0000, v174
    v_xor_b32 v71, v229, v71
    v_lshlrev_b32 v30, 16, v175
    v_and_b32 v31, 0xffff0000, v175
    s_waitcnt vmcnt(11)
    ds_read_b64_tr_b16 v[204:205], v249 offset:1024
    ds_read_b64_tr_b16 v[206:207], v249 offset:1536
    v_mfma_f32_16x16x32_bf16 v[112:115], v[216:219], v[196:199], v[112:115]
    ds_write_b128 v183, v[196:199] offset:33792
    s_waitcnt vmcnt(10)
    ds_read_b64_tr_b16 v[208:209], v250 offset:0
    ds_read_b64_tr_b16 v[210:211], v250 offset:512
    s_waitcnt lgkmcnt(6)
    v_mfma_f32_16x16x32_bf16 v[128:131], v[216:219], v[200:203], v[128:131]
    ds_write_b128 v253, v[200:203] offset:0
    s_waitcnt vmcnt(9)
    ds_read_b64_tr_b16 v[212:213], v250 offset:1024
    ds_read_b64_tr_b16 v[214:215], v250 offset:1536
    s_waitcnt lgkmcnt(6)
    v_mfma_f32_16x16x32_bf16 v[128:131], v[216:219], v[204:207], v[128:131]
    ds_write_b128 v253, v[204:207] offset:1024
    s_waitcnt vmcnt(8)
    ds_read_b64_tr_b16 v[184:185], v251 offset:0
    ds_read_b64_tr_b16 v[186:187], v251 offset:512
    s_waitcnt lgkmcnt(6)
    v_mfma_f32_16x16x32_bf16 v[128:131], v[216:219], v[208:211], v[128:131]
    ds_write_b128 v254, v[208:211] offset:0
    s_waitcnt vmcnt(6)
    ds_read_b64_tr_b16 v[188:189], v251 offset:1024
    ds_read_b64_tr_b16 v[190:191], v251 offset:1536
    s_waitcnt lgkmcnt(6)
    v_mfma_f32_16x16x32_bf16 v[128:131], v[216:219], v[212:215], v[128:131]
    ds_write_b128 v254, v[212:215] offset:1024
    s_waitcnt vmcnt(5)
    ds_read_b64_tr_b16 v[192:193], v177 offset:0
    ds_read_b64_tr_b16 v[194:195], v177 offset:512
    s_waitcnt lgkmcnt(6)
    v_mfma_f32_16x16x32_bf16 v[128:131], v[216:219], v[184:187], v[128:131]
    ds_write_b128 v255, v[184:187] offset:0
    v_lshlrev_b32 v230, 7, v0
    v_lshrrev_b32 v231, 3, v0
    v_lshl_add_u32 v231, v231, 11, v230
    s_lshl_b32 s60, s70, 12
    s_add_u32 s61, s36, s55
    s_add_u32 s61, s61, 32768
    s_mul_i32 s62, s70, 12288
    s_mov_b32 exec_hi, 0
    s_mov_b64 exec, 0xffff
    s_sub_u32 s62, s61, 32768
    buffer_load_dword v99, v230, s[16:19], s62 offen sc1
    s_lshl_b32 s60, s2, 2
    s_add_u32 s60, s60, s30
    s_mul_i32 s61, s60, 1536
    s_lshl_b32 s60, s60, 9
    v_add_u32 v231, s60, v230
    s_mov_b64 exec, 0xfff
    buffer_load_dword v99, v230, s[4:7], s61 offen
    s_mov_b64 exec, 15
    global_load_dword v99, v231, s[52:53]
    global_load_dword v99, v231, s[44:45]
    s_mov_b64 exec, -1
    s_waitcnt vmcnt(8)
    ds_read_b64_tr_b16 v[196:197], v177 offset:1024
    ds_read_b64_tr_b16 v[198:199], v177 offset:1536
    s_waitcnt lgkmcnt(6)
    v_mfma_f32_16x16x32_bf16 v[128:131], v[216:219], v[188:191], v[128:131]
    ds_write_b128 v255, v[188:191] offset:1024
    s_waitcnt vmcnt(7)
    ds_read_b64_tr_b16 v[200:201], v178 offset:0
    ds_read_b64_tr_b16 v[202:203], v178 offset:512
    s_waitcnt lgkmcnt(6)
    v_mfma_f32_16x16x32_bf16 v[144:147], v[216:219], v[192:195], v[144:147]
    ds_write_b128 v181, v[192:195] offset:0
    s_waitcnt vmcnt(6)
    ds_read_b64_tr_b16 v[204:205], v178 offset:1024
    ds_read_b64_tr_b16 v[206:207], v178 offset:1536
    s_waitcnt lgkmcnt(6)
    v_mfma_f32_16x16x32_bf16 v[144:147], v[216:219], v[196:199], v[144:147]
    ds_write_b128 v181, v[196:199] offset:1024
    s_waitcnt vmcnt(5)
    ds_read_b64_tr_b16 v[208:209], v179 offset:0
    ds_read_b64_tr_b16 v[210:211], v179 offset:512
    s_waitcnt lgkmcnt(6)
    v_mfma_f32_16x16x32_bf16 v[144:147], v[216:219], v[200:203], v[144:147]
    ds_write_b128 v182, v[200:203] offset:0
    s_waitcnt vmcnt(4)
    ds_read_b64_tr_b16 v[212:213], v179 offset:1024
    ds_read_b64_tr_b16 v[214:215], v179 offset:1536
    s_waitcnt lgkmcnt(6)
    v_mfma_f32_16x16x32_bf16 v[144:147], v[216:219], v[204:207], v[144:147]
    ds_write_b128 v182, v[204:207] offset:1024
    s_waitcnt lgkmcnt(4)
    v_mfma_f32_16x16x32_bf16 v[144:147], v[216:219], v[208:211], v[144:147]
    ds_write_b128 v183, v[208:211] offset:0
    s_waitcnt lgkmcnt(2)
    v_mfma_f32_16x16x32_bf16 v[144:147], v[216:219], v[212:215], v[144:147]
    ds_write_b128 v183, v[212:215] offset:1024
    s_mul_i32 s63, s30, 0x180
    s_add_u32 s63, s63, 129024
    v_add_u32 v220, s63, v3
    v_cndmask_b32_e64 v112, v113, v112, s[58:59]
    v_cndmask_b32_e64 v128, v129, v128, s[58:59]
    s_nop 1
    v_cndmask_b32_e64 v144, v145, v144, s[58:59]
    ds_write_b32 v220, v144 offset:0
    ds_write_b32 v220, v112 offset:128
    ds_write_b32 v220, v128 offset:256
    s_mov_b32 s8, s4
    s_mov_b32 s9, s5
    s_lshl_b32 s26, s31, 11
    s_add_u32 s26, s26, 18481152
    s_lshl_b32 s61, s29, 7
    s_add_u32 s71, s61, s26
    s_add_u32 s60, s36, 73728
    v_add_u32 v232, s60, v110
    v_lshlrev_b32 v234, 7, v226
    v_add_u32 v233, s26, v234
    v_cndmask_b32_e64 v232, v233, v232, s[58:59]
    s_mov_b32 s39, 0
    s_mov_b32 s34, 1
    s_sub_u32 s35, s64, s31
    s_lshl_b32 s35, s35, 17
    s_mov_b64 exec, 0xffff
    buffer_load_dword v233, v232, s[16:19], 0 offen sc1
    s_mov_b64 exec, -1
    s_waitcnt lgkmcnt(0)
    s_barrier
    v_add_u32 v220, 129024, v3
    ds_read_b32 v184, v220 offset:0
    ds_read_b32 v185, v220 offset:384
    ds_read_b32 v186, v220 offset:768
    ds_read_b32 v187, v220 offset:1152
    ds_read_b32 v188, v220 offset:128
    ds_read_b32 v189, v220 offset:512
    ds_read_b32 v190, v220 offset:896
    ds_read_b32 v191, v220 offset:1280
    ds_read_b32 v192, v220 offset:256
    ds_read_b32 v193, v220 offset:640
    ds_read_b32 v194, v220 offset:1024
    ds_read_b32 v195, v220 offset:1408
    s_waitcnt lgkmcnt(10)
    v_add_f32 v184, v184, v185
    s_waitcnt lgkmcnt(8)
    v_add_f32 v186, v186, v187
    v_add_f32 v184, v184, v186
    s_waitcnt lgkmcnt(6)
    v_add_f32 v188, v188, v189
    s_waitcnt lgkmcnt(4)
    v_add_f32 v190, v190, v191
    v_add_f32 v188, v188, v190
    s_waitcnt lgkmcnt(2)
    v_add_f32 v192, v192, v193
    s_waitcnt lgkmcnt(0)
    v_add_f32 v194, v194, v195
    v_add_f32 v192, v192, v194
    ds_write_b32 v9, v184 offset:0
    ds_write_b32 v9, v188 offset:128
    ds_write_b32 v9, v192 offset:256
    ds_read_b128 v[164:167], v2 offset:0
    ds_read_b128 v[160:163], v1 offset:32768
    ds_read_b128 v[172:175], v2 offset:1024
    ds_read_b128 v[168:171], v1 offset:33792
    ds_read_b128 v[200:203], v8 offset:128
    ds_read_b128 v[204:207], v8 offset:160
    ds_read_b128 v[208:211], v8 offset:192
    ds_read_b128 v[212:215], v8 offset:224
    ds_read_b32 v248, v9 offset:256
    ds_read_b128 a[192:195], v13 offset:0
    ds_read_b128 a[196:199], v13 offset:1024
    ds_read_b128 a[200:203], v13 offset:2048
    ds_read_b128 a[204:207], v13 offset:3072
    ds_read_b128 a[208:211], v13 offset:4096
    ds_read_b128 a[212:215], v13 offset:5120
    ds_read_b128 a[216:219], v13 offset:6144
    ds_read_b128 a[220:223], v13 offset:7168
    ds_read_b128 a[128:131], v12 offset:0
    ds_read_b128 a[132:135], v12 offset:1024
    ds_read_b128 a[136:139], v12 offset:2048
    ds_read_b128 a[140:143], v12 offset:3072
    ds_read_b128 a[144:147], v12 offset:4096
    ds_read_b128 a[148:151], v12 offset:5120
    ds_read_b128 a[152:155], v12 offset:6144
    ds_read_b128 a[156:159], v12 offset:7168
    ds_read_b128 a[160:163], v12 offset:32768
    ds_read_b128 a[164:167], v12 offset:33792
    ds_read_b128 a[168:171], v12 offset:34816
    ds_read_b128 a[172:175], v12 offset:35840
    ds_read_b128 a[176:179], v12 offset:36864
    ds_read_b128 a[180:183], v12 offset:37888
    ds_read_b128 a[184:187], v12 offset:38912
    ds_read_b128 a[188:191], v12 offset:39936
    s_mov_b64 exec, 0xffff
    s_waitcnt vmcnt(0) lgkmcnt(0)
    v_cmp_ne_u32 vcc, s65, v233
    s_mov_b64 exec, -1
    s_cbranch_vccz L_loadx
L_dual:
    s_cmp_eq_u32 s39, 64
    s_cselect_b64 exec, 1, 0
    buffer_store_dword v237, v111, s[16:19], s71 offen sc1
    s_cmp_lt_u32 s39, 64
    s_cselect_b64 exec, 0xffff, -1
    buffer_load_dword v233, v232, s[16:19], 0 offen sc1
    s_add_u32 s39, s39, 1
    s_cmp_ge_u32 s39, 1048576
    s_cbranch_scc1 L_end
    s_waitcnt vmcnt(0)
    s_mov_b64 exec, -1
    v_cmp_ne_u32 vcc, s65, v233
    v_and_b32 v222, -16, v233
    v_cmp_ne_u32 s[60:61], s32, v222
    s_and_b32 s63, vcc_lo, 0xffff
    s_cbranch_scc0 L_loadx
    s_cmp_le_u32 s39, 64
    s_cbranch_scc1 L_dual
    s_lshr_b32 s60, s60, 16
    s_cbranch_scc1 L_dual
    s_lshr_b32 s60, vcc_lo, 16
    s_cbranch_scc0 L_dual
    s_mov_b32 s34, 0
    s_add_u32 s60, s55, s36
    buffer_store_dwordx4 v[240:243], v1, s[16:19], s60 offen sc1
    buffer_store_dwordx4 v[244:247], v1, s[16:19], s60 offen offset:1024 sc1
    buffer_store_dword v236, v7, s[16:19], s36 offen sc1
    s_add_u32 s71, s71, 4294443008
    s_add_u32 s26, s26, 4294443008
    s_mov_b64 exec, 1
    s_waitcnt vmcnt(0)
    buffer_store_dword v237, v111, s[16:19], s71 offen sc1
    s_mov_b64 exec, -1
    s_mov_b32 s39, 0
L_poll_1:
    buffer_load_dword v222, v234, s[16:19], s26 offen offset:0 sc1
    s_add_u32 s39, s39, 1
    s_cmp_ge_u32 s39, 1048576
    s_cbranch_scc1 L_end
    s_waitcnt vmcnt(0)
    v_and_b32 v223, -16, v222
    v_cmp_ne_u32 vcc, s32, v223
    s_nop 0
    s_cbranch_vccnz L_poll_1
    s_nop 1
    s_branch L_loadx
L_layer:
    buffer_load_dword v254, v110, s[16:19], s67 offen sc1
    s_mov_b32 s39, 0
    ds_read_b128 v[164:167], v2 offset:0
    ds_read_b128 v[160:163], v1 offset:32768
    ds_read_b128 v[172:175], v2 offset:1024
    ds_read_b128 v[168:171], v1 offset:33792
    ds_read_b128 v[200:203], v8 offset:128
    ds_read_b128 v[204:207], v8 offset:160
    ds_read_b128 v[208:211], v8 offset:192
    ds_read_b128 v[212:215], v8 offset:224
    ds_read_b32 v248, v9 offset:256
    s_waitcnt lgkmcnt(0)
    buffer_load_dword v255, v110, s[16:19], s67 offen sc1
L_poll_4:
    s_waitcnt vmcnt(1)
    v_cmp_ne_u32 vcc, s32, v254
    s_nop 0
    s_cbranch_vccz L_polldone_5
    buffer_load_dword v254, v110, s[16:19], s67 offen sc1
    s_waitcnt vmcnt(1)
    v_cmp_ne_u32 vcc, s32, v255
    s_nop 0
    s_cbranch_vccz L_polldone_5
    buffer_load_dword v255, v110, s[16:19], s67 offen sc1
    s_add_u32 s39, s39, 1
    s_cmp_lt_u32 s39, 1048576
    s_cbranch_scc1 L_poll_4
    s_branch L_end
L_polldone_5:
L_loadx:
    buffer_load_dwordx4 a[0:3], v1, s[16:19], s36 offen offset:0 sc1
    buffer_load_dwordx4 a[4:7], v1, s[16:19], s36 offen offset:1024 sc1
    buffer_load_dwordx4 a[8:11], v1, s[16:19], s36 offen offset:2048 sc1
    buffer_load_dwordx4 a[12:15], v1, s[16:19], s36 offen offset:3072 sc1
    s_add_u32 s66, s36, 4096
    buffer_load_dwordx4 a[16:19], v1, s[16:19], s66 offen offset:0 sc1
    buffer_load_dwordx4 a[20:23], v1, s[16:19], s66 offen offset:1024 sc1
    buffer_load_dwordx4 a[24:27], v1, s[16:19], s66 offen offset:2048 sc1
    buffer_load_dwordx4 a[28:31], v1, s[16:19], s66 offen offset:3072 sc1
    s_add_u32 s66, s66, 4096
    s_mov_b32 s26, 0
    s_lshl_b32 s63, 1, s33
    s_waitcnt vmcnt(7)
    v_mfma_f32_32x32x16_bf16 v[112:127], v[160:163], a[0:3], 0
    ds_read_b128 v[180:183], v2 offset:2048
    buffer_load_dwordx4 v[184:187], v6, s[16:19], s36 offen offset:0 sc1
    v_mfma_f32_32x32x16_bf16 v[128:143], a[0:3], v[164:167], 0
    ds_read_b128 v[176:179], v1 offset:34816
    buffer_load_dwordx4 v[188:191], v6, s[16:19], s36 offen offset:512 sc1
    s_barrier
    s_waitcnt vmcnt(8)
    v_mfma_f32_32x32x16_bf16 v[112:127], v[168:171], a[4:7], v[112:127]
    ds_read_b128 v[164:167], v2 offset:3072
    buffer_load_dwordx4 v[192:195], v6, s[16:19], s36 offen offset:1024 sc1
    v_mfma_f32_32x32x16_bf16 v[128:143], a[4:7], v[172:175], v[128:143]
    ds_read_b128 v[160:163], v1 offset:35840
    buffer_load_dwordx4 v[196:199], v6, s[16:19], s36 offen offset:1536 sc1
    s_waitcnt vmcnt(9) lgkmcnt(2)
    v_mfma_f32_32x32x16_bf16 v[112:127], v[176:179], a[8:11], v[112:127]
    ds_read_b128 v[172:175], v2 offset:4096
    buffer_load_dwordx4 a[32:35], v1, s[16:19], s66 offen offset:0 sc1
    v_mfma_f32_32x32x16_bf16 v[128:143], a[8:11], v[180:183], v[128:143]
    ds_read_b128 v[168:171], v1 offset:36864
    buffer_load_dwordx4 a[36:39], v1, s[16:19], s66 offen offset:1024 sc1
    s_waitcnt vmcnt(10) lgkmcnt(2)
    v_mfma_f32_32x32x16_bf16 v[112:127], v[160:163], a[12:15], v[112:127]
    ds_read_b128 v[180:183], v2 offset:5120
    buffer_load_dwordx4 a[40:43], v1, s[16:19], s66 offen offset:2048 sc1
    v_mfma_f32_32x32x16_bf16 v[128:143], a[12:15], v[164:167], v[128:143]
    ds_read_b128 v[176:179], v1 offset:37888
    buffer_load_dwordx4 a[44:47], v1, s[16:19], s66 offen offset:3072 sc1
    s_add_u32 s66, s66, 4096
    s_waitcnt vmcnt(11) lgkmcnt(2)
    v_mfma_f32_32x32x16_bf16 v[112:127], v[168:171], a[16:19], v[112:127]
    ds_read_b128 v[164:167], v2 offset:6144
    buffer_load_dwordx4 a[48:51], v1, s[16:19], s66 offen offset:0 sc1
    v_mfma_f32_32x32x16_bf16 v[128:143], a[16:19], v[172:175], v[128:143]
    ds_read_b128 v[160:163], v1 offset:38912
    s_waitcnt vmcnt(11) lgkmcnt(2)
    v_mfma_f32_32x32x16_bf16 v[112:127], v[176:179], a[20:23], v[112:127]
    ds_read_b128 v[172:175], v2 offset:7168
    buffer_load_dwordx4 a[52:55], v1, s[16:19], s66 offen offset:1024 sc1
    v_mfma_f32_32x32x16_bf16 v[128:143], a[20:23], v[180:183], v[128:143]
    ds_read_b128 v[168:171], v1 offset:39936
    s_waitcnt vmcnt(11) lgkmcnt(2)
    v_mfma_f32_32x32x16_bf16 v[112:127], v[160:163], a[24:27], v[112:127]
    ds_read_b128 v[180:183], v2 offset:8192
    buffer_load_dwordx4 a[56:59], v1, s[16:19], s66 offen offset:2048 sc1
    v_mfma_f32_32x32x16_bf16 v[128:143], a[24:27], v[164:167], v[128:143]
    ds_read_b128 v[176:179], v1 offset:40960
    s_waitcnt vmcnt(11) lgkmcnt(2)
    v_mfma_f32_32x32x16_bf16 v[112:127], v[168:171], a[28:31], v[112:127]
    ds_read_b128 v[164:167], v2 offset:9216
    buffer_load_dwordx4 a[60:63], v1, s[16:19], s66 offen offset:3072 sc1
    s_add_u32 s66, s66, 4096
    v_mfma_f32_32x32x16_bf16 v[128:143], a[28:31], v[172:175], v[128:143]
    ds_read_b128 v[160:163], v1 offset:41984
    s_waitcnt vmcnt(7) lgkmcnt(2)
    v_mfma_f32_32x32x16_bf16 v[112:127], v[176:179], a[32:35], v[112:127]
    ds_read_b128 v[172:175], v2 offset:10240
    buffer_load_dwordx4 a[64:67], v1, s[16:19], s66 offen offset:0 sc1
    v_mfma_f32_32x32x16_bf16 v[128:143], a[32:35], v[180:183], v[128:143]
    ds_read_b128 v[168:171], v1 offset:43008
    s_waitcnt vmcnt(7) lgkmcnt(2)
    v_mfma_f32_32x32x16_bf16 v[112:127], v[160:163], a[36:39], v[112:127]
    ds_read_b128 v[180:183], v2 offset:11264
    buffer_load_dwordx4 a[68:71], v1, s[16:19], s66 offen offset:1024 sc1
    v_bitop3_b32 v250, v184, v185, v186 bitop3:0x80
    v_bitop3_b32 v250, v250, v187, v188 bitop3:0x80
    v_bitop3_b32 v250, v250, v189, v190 bitop3:0x80
    v_mfma_f32_32x32x16_bf16 v[128:143], a[36:39], v[164:167], v[128:143]
    ds_read_b128 v[176:179], v1 offset:44032
    v_bitop3_b32 v250, v250, v191, v192 bitop3:0x80
    v_bitop3_b32 v250, v250, v193, v194 bitop3:0x80
    v_bitop3_b32 v250, v250, v195, v196 bitop3:0x80
    v_bitop3_b32 v250, v250, v197, v198 bitop3:0x80
    s_waitcnt vmcnt(7) lgkmcnt(2)
    v_mfma_f32_32x32x16_bf16 v[112:127], v[168:171], a[40:43], v[112:127]
    ds_read_b128 v[164:167], v2 offset:12288
    buffer_load_dwordx4 a[72:75], v1, s[16:19], s66 offen offset:2048 sc1
    v_bitop3_b32 v250, v250, v199, s63 bitop3:0x80
    v_cmp_eq_u32 vcc, 0, v250
    s_nop 0
    s_cbranch_vccnz L_stretry
L_stok:
    v_mfma_f32_32x32x16_bf16 v[128:143], a[40:43], v[172:175], v[128:143]
    ds_read_b128 v[160:163], v1 offset:45056
    v_add_f32 v184, v184, v186
    v_add_f32 v185, v185, v187
    v_add_f32 v184, v184, v188
    v_add_f32 v185, v185, v189
    s_waitcnt vmcnt(7) lgkmcnt(2)
    v_mfma_f32_32x32x16_bf16 v[112:127], v[176:179], a[44:47], v[112:127]
    ds_read_b128 v[172:175], v2 offset:13312
    buffer_load_dwordx4 a[76:79], v1, s[16:19], s66 offen offset:3072 sc1
    s_add_u32 s66, s66, 4096
    v_add_f32 v184, v184, v190
    v_add_f32 v185, v185, v191
    v_mfma_f32_32x32x16_bf16 v[128:143], a[44:47], v[180:183], v[128:143]
    ds_read_b128 v[168:171], v1 offset:46080
    v_add_f32 v184, v184, v192
    v_add_f32 v185, v185, v193
    v_add_f32 v184, v184, v194
    v_add_f32 v185, v185, v195
    s_waitcnt vmcnt(7) lgkmcnt(2)
    v_mfma_f32_32x32x16_bf16 v[112:127], v[160:163], a[48:51], v[112:127]
    ds_read_b128 v[180:183], v2 offset:14336
    buffer_load_dwordx4 a[80:83], v1, s[16:19], s66 offen offset:0 sc1
    v_add_f32 v184, v184, v196
    v_add_f32 v185, v185, v197
    v_add_f32 v184, v184, v198
    v_mfma_f32_32x32x16_bf16 v[128:143], a[48:51], v[164:167], v[128:143]
    ds_read_b128 v[176:179], v1 offset:47104
    v_add_f32 v185, v185, v199
    s_nop 1
    v_permlane32_swap_b32 v184, v185
    v_add_f32 v184, v184, v185
    s_waitcnt vmcnt(7) lgkmcnt(2)
    v_mfma_f32_32x32x16_bf16 v[112:127], v[168:171], a[52:55], v[112:127]
    ds_read_b128 v[164:167], v2 offset:15360
    buffer_load_dwordx4 a[84:87], v1, s[16:19], s66 offen offset:1024 sc1
    v_mov_b32 v185, v184
    s_nop 1
    v_permlane32_swap_b32 v184, v185
    v_mfma_f32_32x32x16_bf16 v[128:143], a[52:55], v[172:175], v[128:143]
    ds_read_b128 v[160:163], v1 offset:48128
    v_mul_f32 v184, 0x3b000000, v184
    v_mul_f32 v185, 0x3b000000, v185
    v_fma_f32 v185, -v184, v184, v185
    v_max_f32 v185, 0, v185
    s_waitcnt vmcnt(7) lgkmcnt(2)
    v_mfma_f32_32x32x16_bf16 v[112:127], v[176:179], a[56:59], v[112:127]
    ds_read_b128 v[172:175], v2 offset:16384
    buffer_load_dwordx4 a[88:91], v1, s[16:19], s66 offen offset:2048 sc1
    v_add_f32 v185, 0x3727c5ac, v185
    v_rsq_f32 v250, v185
    v_mfma_f32_32x32x16_bf16 v[128:143], a[56:59], v[180:183], v[128:143]
    ds_read_b128 v[168:171], v1 offset:49152
    v_mul_f32_e64 v251, -v184, v250
    s_waitcnt vmcnt(7) lgkmcnt(2)
    v_mfma_f32_32x32x16_bf16 v[112:127], v[160:163], a[60:63], v[112:127]
    ds_read_b128 v[180:183], v2 offset:17408
    buffer_load_dwordx4 a[92:95], v1, s[16:19], s66 offen offset:3072 sc1
    s_add_u32 s66, s66, 4096
    ds_write_b32 v10, v250
    ds_write_b32 v10, v251 offset:128
    v_mfma_f32_32x32x16_bf16 v[128:143], a[60:63], v[164:167], v[128:143]
    ds_read_b128 v[176:179], v1 offset:50176
    ds_read_b128 v[232:235], v11 offset:128
    ds_read_b128 v[236:239], v11 offset:160
    ds_read_b128 v[240:243], v11 offset:192
    ds_read_b128 v[244:247], v11 offset:224
    s_waitcnt vmcnt(7) lgkmcnt(8)
    v_mfma_f32_32x32x16_bf16 v[112:127], v[168:171], a[64:67], v[112:127]
    ds_read_b128 v[164:167], v2 offset:18432
    buffer_load_dwordx4 a[96:99], v1, s[16:19], s66 offen offset:0 sc1
    ds_read_b128 v[184:187], v8 offset:0
    ds_read_b128 v[188:191], v8 offset:32
    ds_read_b128 v[192:195], v8 offset:64
    v_mfma_f32_32x32x16_bf16 v[128:143], a[64:67], v[172:175], v[128:143]
    ds_read_b128 v[160:163], v1 offset:51200
    ds_read_b128 v[196:199], v8 offset:96
    ds_read_b128 v[216:219], v11 offset:0
    ds_read_b128 v[220:223], v11 offset:32
    ds_read_b128 v[224:227], v11 offset:64
    s_waitcnt vmcnt(7) lgkmcnt(13)
    v_mfma_f32_32x32x16_bf16 v[112:127], v[176:179], a[68:71], v[112:127]
    ds_read_b128 v[172:175], v2 offset:19456
    buffer_load_dwordx4 a[100:103], v1, s[16:19], s66 offen offset:1024 sc1
    ds_read_b128 v[228:231], v11 offset:96
    v_mul_f32 v252, s37, v250
    v_mul_f32 v253, s37, v251
    v_mfma_f32_32x32x16_bf16 v[128:143], a[68:71], v[180:183], v[128:143]
    ds_read_b128 v[168:171], v1 offset:52224
    v_mul_f32 v250, s56, v250
    v_mul_f32 v251, s56, v251
    v_mul_f32 v200, v200, v251
    v_mul_f32 v201, v201, v251
    s_waitcnt vmcnt(7) lgkmcnt(7)
    v_mfma_f32_32x32x16_bf16 v[112:127], v[160:163], a[72:75], v[112:127]
    ds_read_b128 v[180:183], v2 offset:20480
    buffer_load_dwordx4 a[104:107], v1, s[16:19], s66 offen offset:2048 sc1
    v_mul_f32 v202, v202, v251
    v_mul_f32 v203, v203, v251
    v_mul_f32 v204, v204, v251
    v_mfma_f32_32x32x16_bf16 v[128:143], a[72:75], v[164:167], v[128:143]
    ds_read_b128 v[176:179], v1 offset:53248
    v_mul_f32 v205, v205, v251
    v_mul_f32 v206, v206, v251
    v_mul_f32 v207, v207, v251
    v_mul_f32 v208, v208, v251
    s_waitcnt vmcnt(7) lgkmcnt(2)
    v_mfma_f32_32x32x16_bf16 v[112:127], v[168:171], a[76:79], v[112:127]
    ds_read_b128 v[164:167], v2 offset:21504
    buffer_load_dwordx4 a[108:111], v1, s[16:19], s66 offen offset:3072 sc1
    s_add_u32 s66, s66, 4096
    v_mul_f32 v209, v209, v251
    v_mul_f32 v210, v210, v251
    v_mfma_f32_32x32x16_bf16 v[128:143], a[76:79], v[172:175], v[128:143]
    ds_read_b128 v[160:163], v1 offset:54272
    v_mul_f32 v211, v211, v251
    v_mul_f32 v212, v212, v251
    v_mul_f32 v213, v213, v251
    v_mul_f32 v214, v214, v251
    s_waitcnt vmcnt(7) lgkmcnt(2)
    v_mfma_f32_32x32x16_bf16 v[112:127], v[176:179], a[80:83], v[112:127]
    ds_read_b128 v[172:175], v2 offset:22528
    buffer_load_dwordx4 a[112:115], v1, s[16:19], s66 offen offset:0 sc1
    v_mul_f32 v215, v215, v251
    v_mul_f32 v232, v232, v248
    v_mul_f32 v233, v233, v248
    v_mfma_f32_32x32x16_bf16 v[128:143], a[80:83], v[180:183], v[128:143]
    ds_read_b128 v[168:171], v1 offset:55296
    v_mul_f32 v234, v234, v248
    v_mul_f32 v235, v235, v248
    v_mul_f32 v236, v236, v248
    v_mul_f32 v237, v237, v248
    s_waitcnt vmcnt(7) lgkmcnt(2)
    v_mfma_f32_32x32x16_bf16 v[112:127], v[160:163], a[84:87], v[112:127]
    ds_read_b128 v[180:183], v2 offset:23552
    buffer_load_dwordx4 a[116:119], v1, s[16:19], s66 offen offset:1024 sc1
    v_mul_f32 v238, v238, v248
    v_mul_f32 v239, v239, v248
    v_mul_f32 v240, v240, v248
    v_mfma_f32_32x32x16_bf16 v[128:143], a[84:87], v[164:167], v[128:143]
    ds_read_b128 v[176:179], v1 offset:56320
    v_mul_f32 v241, v241, v248
    v_mul_f32 v242, v242, v248
    v_mul_f32 v243, v243, v248
    v_mul_f32 v244, v244, v248
    s_waitcnt vmcnt(7) lgkmcnt(2)
    v_mfma_f32_32x32x16_bf16 v[112:127], v[168:171], a[88:91], v[112:127]
    ds_read_b128 v[164:167], v2 offset:24576
    buffer_load_dwordx4 a[120:123], v1, s[16:19], s66 offen offset:2048 sc1
    v_mul_f32 v245, v245, v248
    v_mul_f32 v246, v246, v248
    v_mul_f32 v247, v247, v248
    v_mfma_f32_32x32x16_bf16 v[128:143], a[88:91], v[172:175], v[128:143]
    ds_read_b128 v[160:163], v1 offset:57344
    v_mul_f32 v184, v184, v253
    v_mul_f32 v185, v185, v253
    v_mul_f32 v186, v186, v253
    v_mul_f32 v187, v187, v253
    s_waitcnt vmcnt(7) lgkmcnt(2)
    v_mfma_f32_32x32x16_bf16 v[112:127], v[176:179], a[92:95], v[112:127]
    ds_read_b128 v[172:175], v2 offset:25600
    buffer_load_dwordx4 a[124:127], v1, s[16:19], s66 offen offset:3072 sc1
    v_mul_f32 v188, v188, v253
    v_mul_f32 v189, v189, v253
    v_mul_f32 v190, v190, v253
    v_mfma_f32_32x32x16_bf16 v[128:143], a[92:95], v[180:183], v[128:143]
    ds_read_b128 v[168:171], v1 offset:58368
    s_lshl_b32 s60, s30, 13
    s_add_u32 m0, s60, 131072
    s_mov_b32 s61, 0
    buffer_load_dwordx4 v5, s[12:15], s61 offen offset:0 lds
    s_waitcnt vmcnt(8) lgkmcnt(2)
    v_mfma_f32_32x32x16_bf16 v[112:127], v[160:163], a[96:99], v[112:127]
    ds_read_b128 v[180:183], v2 offset:26624
    v_mul_f32 v191, v191, v253
    v_mul_f32 v192, v192, v253
    v_mul_f32 v193, v193, v253
    v_mul_f32 v194, v194, v253
    v_mfma_f32_32x32x16_bf16 v[128:143], a[96:99], v[164:167], v[128:143]
    ds_read_b128 v[176:179], v1 offset:59392
    s_add_u32 s61, s61, 7168
    buffer_load_dwordx4 v5, s[12:15], s61 offen offset:1024 lds
    v_mul_f32 v195, v195, v253
    v_mul_f32 v196, v196, v253
    s_waitcnt vmcnt(8) lgkmcnt(2)
    v_mfma_f32_32x32x16_bf16 v[112:127], v[168:171], a[100:103], v[112:127]
    ds_read_b128 v[164:167], v2 offset:27648
    v_mul_f32 v197, v197, v253
    v_mul_f32 v198, v198, v253
    v_mul_f32 v199, v199, v253
    v_mfma_f32_32x32x16_bf16 v[128:143], a[100:103], v[172:175], v[128:143]
    ds_read_b128 v[160:163], v1 offset:60416
    s_add_u32 s61, s61, 7168
    buffer_load_dwordx4 v5, s[12:15], s61 offen offset:2048 lds
    s_waitcnt vmcnt(8) lgkmcnt(2)
    v_mfma_f32_32x32x16_bf16 v[112:127], v[176:179], a[104:107], v[112:127]
    ds_read_b128 v[172:175], v2 offset:28672
    v_mfma_f32_32x32x16_bf16 v[128:143], a[104:107], v[180:183], v[128:143]
    ds_read_b128 v[168:171], v1 offset:61440
    s_add_u32 s61, s61, 7168
    buffer_load_dwordx4 v5, s[12:15], s61 offen offset:3072 lds
    s_waitcnt vmcnt(8) lgkmcnt(2)
    v_mfma_f32_32x32x16_bf16 v[112:127], v[160:163], a[108:111], v[112:127]
    ds_read_b128 v[180:183], v2 offset:29696
    v_mfma_f32_32x32x16_bf16 v[128:143], a[108:111], v[164:167], v[128:143]
    ds_read_b128 v[176:179], v1 offset:62464
    s_add_u32 m0, m0, 4096
    s_add_u32 s61, s61, 11264
    buffer_load_dwordx4 v5, s[12:15], s61 offen offset:0 lds
    s_waitcnt vmcnt(8) lgkmcnt(2)
    v_mfma_f32_32x32x16_bf16 v[112:127], v[168:171], a[112:115], v[112:127]
    ds_read_b128 v[164:167], v2 offset:30720
    v_mfma_f32_32x32x16_bf16 v[128:143], a[112:115], v[172:175], v[128:143]
    ds_read_b128 v[160:163], v1 offset:63488
    s_add_u32 s61, s61, 7168
    buffer_load_dwordx4 v5, s[12:15], s61 offen offset:1024 lds
    s_waitcnt vmcnt(8) lgkmcnt(2)
    v_mfma_f32_32x32x16_bf16 v[112:127], v[176:179], a[116:119], v[112:127]
    ds_read_b128 v[172:175], v2 offset:31744
    v_mfma_f32_32x32x16_bf16 v[128:143], a[116:119], v[180:183], v[128:143]
    ds_read_b128 v[168:171], v1 offset:64512
    s_add_u32 s61, s61, 7168
    buffer_load_dwordx4 v5, s[12:15], s61 offen offset:2048 lds
    s_waitcnt vmcnt(8) lgkmcnt(2)
    v_mfma_f32_32x32x16_bf16 v[112:127], v[160:163], a[120:123], v[112:127]
    ds_read_b128 v[176:179], v1 offset:0
    v_mfma_f32_32x32x16_bf16 v[128:143], a[120:123], v[164:167], v[128:143]
    ds_read_b128 v[180:183], v1 offset:1024
    s_add_u32 s61, s61, 7168
    buffer_load_dwordx4 v5, s[12:15], s61 offen offset:3072 lds
    s_waitcnt vmcnt(8) lgkmcnt(2)
    v_mfma_f32_32x32x16_bf16 v[112:127], v[168:171], a[124:127], v[112:127]
    ds_read_b128 v[160:163], v1 offset:2048
    v_mfma_f32_32x32x16_bf16 v[128:143], a[124:127], v[172:175], v[128:143]
    ds_read_b128 v[164:167], v1 offset:3072
    s_bitcmp1_b32 s33, 0
    s_cbranch_scc1 L_layerB
    s_waitcnt lgkmcnt(2)
    v_mfma_f32_32x32x16_bf16 v[144:159], v[176:179], a[0:3], 0
    ds_read_b128 v[168:171], v1 offset:4096
    s_nop 3
    v_fmac_f32 v200, v112, v250
    v_fmac_f32 v201, v113, v250
    v_fmac_f32 v202, v114, v250
    v_fmac_f32 v203, v115, v250
    v_mfma_f32_32x32x16_bf16 v[144:159], v[180:183], a[4:7], v[144:159]
    ds_read_b128 v[172:175], v1 offset:5120
    v_fmac_f32 v204, v116, v250
    v_fmac_f32 v205, v117, v250
    v_fmac_f32 v206, v118, v250
    v_fmac_f32 v207, v119, v250
    s_waitcnt lgkmcnt(2)
    v_mfma_f32_32x32x16_bf16 v[144:159], v[160:163], a[8:11], v[144:159]
    ds_read_b128 v[176:179], v1 offset:6144
    v_fmac_f32 v208, v120, v250
    v_fmac_f32 v209, v121, v250
    v_fmac_f32 v210, v122, v250
    v_fmac_f32 v211, v123, v250
    v_fmac_f32 v212, v124, v250
    v_fmac_f32 v213, v125, v250
    v_fmac_f32 v214, v126, v250
    v_fmac_f32 v215, v127, v250
    v_cvt_pk_bf16_f32 v112, v200, v201
    v_cvt_pk_bf16_f32 v113, v202, v203
    v_cvt_pk_bf16_f32 v114, v204, v205
    v_cvt_pk_bf16_f32 v115, v206, v207
    v_mfma_f32_32x32x16_bf16 v[144:159], v[164:167], a[12:15], v[144:159]
    ds_read_b128 v[180:183], v1 offset:7168
    v_cvt_pk_bf16_f32 v116, v208, v209
    v_cvt_pk_bf16_f32 v117, v210, v211
    v_cvt_pk_bf16_f32 v118, v212, v213
    v_cvt_pk_bf16_f32 v119, v214, v215
    s_waitcnt lgkmcnt(2)
    v_mfma_f32_32x32x16_bf16 v[144:159], v[168:171], a[16:19], v[144:159]
    ds_read_b128 v[160:163], v1 offset:8192
    buffer_store_dwordx4 v[112:115], v1, s[16:19], s40 offen offset:0 sc1
    buffer_store_dwordx4 v[116:119], v1, s[16:19], s40 offen offset:1024 sc1
    v_fmac_f32 v232, v128, v216
    v_fmac_f32 v233, v129, v217
    v_fmac_f32 v234, v130, v218
    v_fmac_f32 v235, v131, v219
    v_fmac_f32 v236, v132, v220
    v_fmac_f32 v237, v133, v221
    v_fmac_f32 v238, v134, v222
    v_fmac_f32 v239, v135, v223
    v_mfma_f32_32x32x16_bf16 v[144:159], v[172:175], a[20:23], v[144:159]
    ds_read_b128 v[164:167], v1 offset:9216
    v_fmac_f32 v240, v136, v224
    v_fmac_f32 v241, v137, v225
    v_fmac_f32 v242, v138, v226
    v_fmac_f32 v243, v139, v227
    v_fmac_f32 v244, v140, v228
    v_fmac_f32 v245, v141, v229
    v_fmac_f32 v246, v142, v230
    v_fmac_f32 v247, v143, v231
    v_cvt_pk_bf16_f32 v120, v232, v233
    v_cvt_pk_bf16_f32 v121, v234, v235
    v_cvt_pk_bf16_f32 v122, v236, v237
    v_cvt_pk_bf16_f32 v123, v238, v239
    s_waitcnt lgkmcnt(2)
    v_mfma_f32_32x32x16_bf16 v[144:159], v[176:179], a[24:27], v[144:159]
    ds_read_b128 v[168:171], v1 offset:10240
    v_cvt_pk_bf16_f32 v124, v240, v241
    v_cvt_pk_bf16_f32 v125, v242, v243
    v_cvt_pk_bf16_f32 v126, v244, v245
    v_cvt_pk_bf16_f32 v127, v246, v247
    v_mfma_f32_32x32x16_bf16 v[144:159], v[180:183], a[28:31], v[144:159]
    ds_read_b128 v[172:175], v1 offset:11264
    buffer_store_dwordx4 v[120:123], v1, s[16:19], s40 offen offset:2048 sc1
    buffer_store_dwordx4 v[124:127], v1, s[16:19], s40 offen offset:3072 sc1
    v_mul_f32 v216, v200, v200
    v_mul_f32 v217, v208, v208
    v_fmac_f32 v216, v201, v201
    v_fmac_f32 v217, v209, v209
    v_fmac_f32 v216, v202, v202
    v_fmac_f32 v217, v210, v210
    v_fmac_f32 v216, v203, v203
    v_fmac_f32 v217, v211, v211
    s_waitcnt lgkmcnt(2)
    v_mfma_f32_32x32x16_bf16 v[144:159], v[160:163], a[32:35], v[144:159]
    ds_read_b128 v[176:179], v1 offset:12288
    v_fmac_f32 v216, v204, v204
    v_fmac_f32 v217, v212, v212
    v_fmac_f32 v216, v205, v205
    v_fmac_f32 v217, v213, v213
    v_fmac_f32 v216, v206, v206
    v_fmac_f32 v217, v214, v214
    v_fmac_f32 v216, v207, v207
    v_fmac_f32 v217, v215, v215
    v_max_u32 v216, v216, v217
    v_cmp_lt_u32 vcc, 0x42d95ef7, v216
    s_nop 0
    s_cmp_lg_u64 vcc, 0
    s_cselect_b32 s26, 1, s26
    v_mfma_f32_32x32x16_bf16 v[144:159], v[164:167], a[36:39], v[144:159]
    ds_read_b128 v[180:183], v1 offset:13312
    v_add3_u32 v250, v112, v113, v96
    v_add3_u32 v250, v250, v114, v115
    v_add3_u32 v250, v250, v116, v117
    v_add3_u32 v250, v250, v118, v119
    v_add3_u32 v250, v250, v120, v121
    v_add3_u32 v250, v250, v122, v123
    v_add3_u32 v250, v250, v124, v125
    v_add3_u32 v250, v250, v126, v127
    v_add_u32 v250, s26, v250
    v_lshlrev_b32 v249, 2, v0
    s_waitcnt lgkmcnt(2)
    v_mfma_f32_32x32x16_bf16 v[144:159], v[168:171], a[40:43], v[144:159]
    ds_read_b128 v[160:163], v1 offset:14336
    buffer_store_dword v250, v249, s[16:19], s41 offen sc1
    v_mfma_f32_32x32x16_bf16 v[144:159], v[172:175], a[44:47], v[144:159]
    ds_read_b128 v[164:167], v1 offset:15360
    s_cmp_lt_u32 s33, 1
    s_cbranch_scc1 L_stub0
L_stubret0:
    s_waitcnt lgkmcnt(2)
    v_mfma_f32_32x32x16_bf16 v[144:159], v[176:179], a[48:51], v[144:159]
    ds_read_b128 v[168:171], v1 offset:16384
    s_mul_i32 s63, s30, 4128
    s_add_u32 s63, s63, 98560
    v_mfma_f32_32x32x16_bf16 v[144:159], v[180:183], a[52:55], v[144:159]
    ds_read_b128 v[172:175], v1 offset:17408
    v_add_u32 v251, s63, v1
    v_lshl_add_u32 v248, v0, 10, v251
    s_waitcnt lgkmcnt(2)
    v_mfma_f32_32x32x16_bf16 v[144:159], v[160:163], a[56:59], v[144:159]
    ds_read_b128 v[176:179], v1 offset:18432
    ds_write_b128 v251, v[112:115] offset:0
    v_mfma_f32_32x32x16_bf16 v[144:159], v[164:167], a[60:63], v[144:159]
    ds_read_b128 v[180:183], v1 offset:19456
    ds_write_b128 v251, v[116:119] offset:1024
    s_waitcnt lgkmcnt(4)
    v_mfma_f32_32x32x16_bf16 v[144:159], v[168:171], a[64:67], v[144:159]
    ds_read_b128 v[160:163], v1 offset:20480
    ds_write_b128 v251, v[120:123] offset:2048
    v_mfma_f32_32x32x16_bf16 v[144:159], v[172:175], a[68:71], v[144:159]
    ds_read_b128 v[164:167], v1 offset:21504
    ds_write_b128 v251, v[124:127] offset:3088
    s_waitcnt lgkmcnt(5)
    v_mfma_f32_32x32x16_bf16 v[144:159], v[176:179], a[72:75], v[144:159]
    ds_read_b128 v[168:171], v1 offset:22528
    s_mov_b64 exec, 3
    ds_write_b128 v248, v[80:83] offset:3072
    s_mov_b64 exec, -1
    v_mfma_f32_32x32x16_bf16 v[144:159], v[180:183], a[76:79], v[144:159]
    ds_read_b128 v[172:175], v1 offset:23552
    s_waitcnt lgkmcnt(4)
    v_mfma_f32_32x32x16_bf16 v[144:159], v[160:163], a[80:83], v[144:159]
    ds_read_b128 v[176:179], v1 offset:24576
    v_mfma_f32_32x32x16_bf16 v[144:159], v[164:167], a[84:87], v[144:159]
    ds_read_b128 v[180:183], v1 offset:25600
    s_waitcnt lgkmcnt(2)
    v_mfma_f32_32x32x16_bf16 v[144:159], v[168:171], a[88:91], v[144:159]
    ds_read_b128 v[160:163], v1 offset:26624
    v_mfma_f32_32x32x16_bf16 v[144:159], v[172:175], a[92:95], v[144:159]
    ds_read_b128 v[164:167], v1 offset:27648
    s_waitcnt lgkmcnt(2)
    v_mfma_f32_32x32x16_bf16 v[144:159], v[176:179], a[96:99], v[144:159]
    ds_read_b128 v[168:171], v1 offset:28672
    v_mfma_f32_32x32x16_bf16 v[144:159], v[180:183], a[100:103], v[144:159]
    ds_read_b128 v[172:175], v1 offset:29696
    s_waitcnt lgkmcnt(2)
    v_mfma_f32_32x32x16_bf16 v[144:159], v[160:163], a[104:107], v[144:159]
    ds_read_b128 v[176:179], v1 offset:30720
    v_mfma_f32_32x32x16_bf16 v[144:159], v[164:167], a[108:111], v[144:159]
    ds_read_b128 v[180:183], v1 offset:31744
    s_waitcnt lgkmcnt(2)
    v_mfma_f32_32x32x16_bf16 v[144:159], v[168:171], a[112:115], v[144:159]
    s_cmp_lt_u32 s33, 1
    s_cbranch_scc1 L_stub1
    s_waitcnt vmcnt(5)
L_stubret1:
    s_add_u32 s68, s42, 0x20000
    s_add_u32 s69, s43, 0x4000
    v_mfma_f32_32x32x16_bf16 v[144:159], v[172:175], a[116:119], v[144:159]
    s_waitcnt lgkmcnt(0)
    v_mfma_f32_32x32x16_bf16 v[144:159], v[176:179], a[120:123], v[144:159]
    v_mfma_f32_32x32x16_bf16 v[144:159], v[180:183], a[124:127], v[144:159]
    s_nop 11
    v_pk_fma_f32 v[184:185], v[144:145], v[252:253], v[184:185] op_sel:[0,0,0] op_sel_hi:[1,0,1]
    v_pk_fma_f32 v[186:187], v[146:147], v[252:253], v[186:187] op_sel:[0,0,0] op_sel_hi:[1,0,1]
    v_pk_fma_f32 v[188:189], v[148:149], v[252:253], v[188:189] op_sel:[0,0,0] op_sel_hi:[1,0,1]
    v_pk_fma_f32 v[190:191], v[150:151], v[252:253], v[190:191] op_sel:[0,0,0] op_sel_hi:[1,0,1]
    v_pk_fma_f32 v[192:193], v[152:153], v[252:253], v[192:193] op_sel:[0,0,0] op_sel_hi:[1,0,1]
    v_pk_fma_f32 v[194:195], v[154:155], v[252:253], v[194:195] op_sel:[0,0,0] op_sel_hi:[1,0,1]
    v_pk_fma_f32 v[196:197], v[156:157], v[252:253], v[196:197] op_sel:[0,0,0] op_sel_hi:[1,0,1]
    v_pk_fma_f32 v[198:199], v[158:159], v[252:253], v[198:199] op_sel:[0,0,0] op_sel_hi:[1,0,1]
    v_cvt_pk_bf16_f32 v128, v184, v185
    v_cvt_pk_bf16_f32 v129, v186, v187
    v_cvt_pk_bf16_f32 v130, v188, v189
    v_cvt_pk_bf16_f32 v131, v190, v191
    v_cvt_pk_bf16_f32 v132, v192, v193
    v_cvt_pk_bf16_f32 v133, v194, v195
    v_cvt_pk_bf16_f32 v134, v196, v197
    v_cvt_pk_bf16_f32 v135, v198, v199
    ds_write_b128 v101, v[128:131]
    ds_write_b128 v101, v[132:135] offset:1024
    v_pk_mul_f32 v[244:245], v[184:185], v[184:185]
    v_pk_fma_f32 v[244:245], v[186:187], v[186:187], v[244:245]
    v_pk_fma_f32 v[244:245], v[188:189], v[188:189], v[244:245]
    v_pk_fma_f32 v[244:245], v[190:191], v[190:191], v[244:245]
    v_pk_mul_f32 v[246:247], v[192:193], v[192:193]
    v_pk_fma_f32 v[246:247], v[194:195], v[194:195], v[246:247]
    v_pk_fma_f32 v[246:247], v[196:197], v[196:197], v[246:247]
    v_pk_fma_f32 v[246:247], v[198:199], v[198:199], v[246:247]
    v_add_f32 v244, v244, v245
    v_add_f32 v245, v246, v247
    v_max_u32 v244, v244, v245
    v_cmp_lt_u32 vcc, 0x416236ef, v244
    s_nop 0
    s_cmp_lg_u64 vcc, 0
    s_cselect_b32 s26, 1, s26
    v_mov_b32 v248, s26
    ds_write_b32 v102, v248
    s_cmp_eq_u32 s33, 0
    s_cselect_b64 vcc, -1, 0
    s_waitcnt lgkmcnt(0)
    s_barrier
    ds_read_b128 v[116:119], v108
    ds_read_b128 v[192:195], v104 offset:33024
    ds_read_b128 v[196:199], v104 offset:28896
    ds_read_b128 v[112:115], v107
    v_mov_b32 v248, 123264
    s_lshl_b32 s66, s30, 13
    s_lshl_b32 s60, s30, 6
    v_add_u32 v253, s60, v13
    v_lshl_add_u32 v254, v0, 10, v253
    s_mov_b64 exec, 3
    ds_write_b128 v254, v[80:83] offset:3072
    ds_write_b128 v254, v[80:83] offset:7200
    s_mov_b64 exec, -1
    s_waitcnt lgkmcnt(4)
    v_mfma_f32_32x32x16_bf16 v[120:135], v[192:195], v[116:119], v[32:47]
    ds_read_b128 v[88:91], v106 offset:33024
    ds_read_b128 v[92:95], v106 offset:34064
    s_cbranch_vccnz L_stub2
L_stubret2:
    s_nop 8
    v_exp_f32 v120, v120
    v_exp_f32 v121, v121
    v_exp_f32 v122, v122
    v_exp_f32 v123, v123
    v_exp_f32 v124, v124
    v_cvt_pk_bf16_f32 v152, v120, v121
    v_exp_f32 v125, v125
    v_exp_f32 v126, v126
    v_cvt_pk_bf16_f32 v153, v122, v123
    v_exp_f32 v127, v127
    s_waitcnt lgkmcnt(5)
    v_mfma_f32_32x32x16_bf16 v[136:151], v[196:199], v[116:119], 0
    ds_read_b128 v[200:203], v104 offset:24768
    v_exp_f32 v128, v128
    v_cvt_pk_bf16_f32 v154, v124, v125
    v_exp_f32 v129, v129
    v_exp_f32 v130, v130
    v_cvt_pk_bf16_f32 v155, v126, v127
    v_exp_f32 v131, v131
    v_exp_f32 v132, v132
    v_cvt_pk_bf16_f32 v156, v128, v129
    v_exp_f32 v133, v133
    v_exp_f32 v134, v134
    v_cvt_pk_bf16_f32 v157, v130, v131
    v_exp_f32 v135, v135
    v_cvt_pk_bf16_f32 v158, v132, v133
    v_cvt_pk_bf16_f32 v159, v134, v135
    s_waitcnt lgkmcnt(0)
    v_mfma_f32_32x32x16_bf16 v[176:191], v[88:91], v[152:155], 0
    v_exp_f32 v136, v136
    v_exp_f32 v137, v137
    v_exp_f32 v138, v138
    v_exp_f32 v139, v139
    v_mfma_f32_32x32x16_bf16 v[176:191], v[92:95], v[156:159], v[176:191]
    ds_read_b128 v[88:91], v106 offset:28896
    ds_read_b128 v[92:95], v106 offset:29936
    buffer_load_dwordx4 v[204:207], v1, s[16:19], s42 offen offset:0
    buffer_load_dwordx4 v[208:211], v1, s[16:19], s42 offen offset:1024
    v_exp_f32 v140, v140
    v_cvt_pk_bf16_f32 v152, v136, v137
    v_exp_f32 v141, v141
    v_exp_f32 v142, v142
    v_cvt_pk_bf16_f32 v153, v138, v139
    v_exp_f32 v143, v143
    v_mfma_f32_32x32x16_bf16 v[120:135], v[200:203], v[116:119], 0
    ds_read_b128 v[192:195], v103 offset:33024
    buffer_load_dwordx4 v[220:223], v1, s[16:19], s68 offen offset:0
    v_exp_f32 v144, v144
    v_cvt_pk_bf16_f32 v154, v140, v141
    v_exp_f32 v145, v145
    v_exp_f32 v146, v146
    v_cvt_pk_bf16_f32 v155, v142, v143
    v_exp_f32 v147, v147
    v_exp_f32 v148, v148
    v_cvt_pk_bf16_f32 v156, v144, v145
    v_exp_f32 v149, v149
    v_exp_f32 v150, v150
    v_cvt_pk_bf16_f32 v157, v146, v147
    v_exp_f32 v151, v151
    v_cvt_pk_bf16_f32 v158, v148, v149
    v_cvt_pk_bf16_f32 v159, v150, v151
    s_waitcnt lgkmcnt(0)
    v_mfma_f32_32x32x16_bf16 v[176:191], v[88:91], v[152:155], v[176:191]
    buffer_load_dwordx4 v[224:227], v1, s[16:19], s68 offen offset:1024
    buffer_load_dwordx4 v[212:215], v1, s[16:19], s42 offen offset:2048
    v_exp_f32 v120, v120
    v_exp_f32 v121, v121
    v_exp_f32 v122, v122
    v_exp_f32 v123, v123
    v_mfma_f32_32x32x16_bf16 v[176:191], v[92:95], v[156:159], v[176:191]
    ds_read_b128 v[88:91], v106 offset:24768
    ds_read_b128 v[92:95], v106 offset:25808
    buffer_load_dwordx4 v[216:219], v1, s[16:19], s42 offen offset:3072
    v_exp_f32 v124, v124
    v_cvt_pk_bf16_f32 v152, v120, v121
    v_exp_f32 v125, v125
    v_exp_f32 v126, v126
    v_cvt_pk_bf16_f32 v153, v122, v123
    v_exp_f32 v127, v127
    v_mfma_f32_32x32x16_bf16 v[136:151], v[192:195], v[112:115], v[32:47]
    buffer_load_dwordx4 v[228:231], v1, s[16:19], s68 offen offset:2048
    buffer_load_dwordx4 v[232:235], v1, s[16:19], s68 offen offset:3072
    v_exp_f32 v128, v128
    v_cvt_pk_bf16_f32 v154, v124, v125
    v_exp_f32 v129, v129
    v_exp_f32 v130, v130
    v_cvt_pk_bf16_f32 v155, v126, v127
    v_exp_f32 v131, v131
    v_exp_f32 v132, v132
    v_cvt_pk_bf16_f32 v156, v128, v129
    v_exp_f32 v133, v133
    v_exp_f32 v134, v134
    v_cvt_pk_bf16_f32 v157, v130, v131
    v_exp_f32 v135, v135
    v_cvt_pk_bf16_f32 v158, v132, v133
    v_cvt_pk_bf16_f32 v159, v134, v135
    s_waitcnt lgkmcnt(0)
    v_mfma_f32_32x32x16_bf16 v[176:191], v[88:91], v[152:155], v[176:191]
    buffer_load_dword v236, v249, s[16:19], s43 offen
    buffer_load_dword v238, v249, s[16:19], s69 offen
    ds_read_b64_tr_b16 a[4:5], v98 offset:0
    ds_read_b64_tr_b16 a[10:11], v109 offset:3072
    ds_read_b64_tr_b16 a[16:17], v109 offset:4096
    ds_read_b64_tr_b16 a[22:23], v98 offset:5120
    v_exp_f32 v136, v136
    v_exp_f32 v137, v137
    v_exp_f32 v138, v138
    v_exp_f32 v139, v139
    v_mfma_f32_32x32x16_bf16 v[176:191], v[92:95], v[156:159], v[176:191]
    ds_read_b128 v[80:83], v105 offset:33024
    ds_read_b128 v[84:87], v105 offset:34064
    ds_read_b64_tr_b16 a[2:3], v109 offset:1024
    ds_read_b64_tr_b16 a[8:9], v109 offset:2048
    ds_read_b64_tr_b16 a[14:15], v98 offset:3072
    ds_read_b64_tr_b16 a[20:21], v98 offset:4096
    v_exp_f32 v140, v140
    v_cvt_pk_bf16_f32 v152, v136, v137
    v_exp_f32 v141, v141
    v_exp_f32 v142, v142
    v_cvt_pk_bf16_f32 v153, v138, v139
    v_exp_f32 v143, v143
    ds_read_b64_tr_b16 a[0:1], v109 offset:0
    ds_read_b64_tr_b16 a[6:7], v98 offset:1024
    ds_read_b64_tr_b16 a[12:13], v98 offset:2048
    ds_read_b64_tr_b16 a[18:19], v109 offset:5120
    v_exp_f32 v144, v144
    v_cvt_pk_bf16_f32 v154, v140, v141
    v_exp_f32 v145, v145
    v_exp_f32 v146, v146
    v_cvt_pk_bf16_f32 v155, v142, v143
    v_exp_f32 v147, v147
    v_exp_f32 v148, v148
    s_waitcnt lgkmcnt(9)
    v_mfma_f32_32x32x16_bf16 v[160:175], v[80:83], v[152:155], 0
    v_cvt_pk_bf16_f32 v156, v144, v145
    v_exp_f32 v149, v149
    v_exp_f32 v150, v150
    v_cvt_pk_bf16_f32 v157, v146, v147
    v_exp_f32 v151, v151
    v_cvt_pk_bf16_f32 v158, v148, v149
    v_cvt_pk_bf16_f32 v159, v150, v151
    s_waitcnt lgkmcnt(8)
    s_nop 0
    v_mfma_f32_32x32x16_bf16 v[160:175], v[84:87], v[156:159], v[160:175]
    ds_read_b64_tr_b16 a[24:25], v109 offset:6144
    ds_read_b64_tr_b16 a[26:27], v109 offset:7168
    ds_read_b64_tr_b16 a[28:29], v98 offset:6144
    ds_read_b64_tr_b16 a[30:31], v98 offset:7168
    ds_read_b64_tr_b16 a[32:33], v109 offset:8192
    ds_read_b64_tr_b16 a[34:35], v109 offset:9216
    ds_read_b64_tr_b16 a[36:37], v98 offset:8192
    ds_read_b64_tr_b16 a[38:39], v98 offset:9216
    ds_read_b64_tr_b16 a[40:41], v109 offset:10240
    ds_read_b64_tr_b16 a[42:43], v109 offset:11264
    ds_read_b64_tr_b16 a[44:45], v98 offset:10240
    ds_read_b64_tr_b16 a[46:47], v98 offset:11264
    ds_read_b64_tr_b16 a[48:49], v109 offset:12288
    ds_read_b64_tr_b16 a[50:51], v109 offset:13312
    ds_read_b64_tr_b16 a[52:53], v98 offset:12288
    ds_read_b64_tr_b16 a[54:55], v98 offset:13312
    ds_read_b64_tr_b16 a[56:57], v109 offset:14336
    ds_read_b64_tr_b16 a[58:59], v109 offset:15360
    ds_read_b64_tr_b16 a[60:61], v98 offset:14336
    ds_read_b64_tr_b16 a[62:63], v98 offset:15360
    s_cmp_lt_i32 s27, 0
    s_cbranch_scc1 L_virt
    s_mov_b32 s71, 0
L_hcheck:
    s_waitcnt vmcnt(9)
    ds_write_b128 v253, v[204:207] offset:0
    v_add3_u32 v250, v204, v205, v96
    v_add3_u32 v250, v250, v206, v207
    s_waitcnt vmcnt(8)
    ds_write_b128 v253, v[208:211] offset:1024
    v_add3_u32 v250, v208, v209, v250
    v_add3_u32 v250, v250, v210, v211
    s_waitcnt vmcnt(7)
    ds_write_b128 v253, v[220:223] offset:4128
    v_add3_u32 v251, v220, v221, v96
    v_add3_u32 v251, v251, v222, v223
    s_waitcnt vmcnt(6)
    ds_write_b128 v253, v[224:227] offset:5152
    v_add3_u32 v251, v224, v225, v251
    v_add3_u32 v251, v251, v226, v227
    s_waitcnt vmcnt(5)
    ds_write_b128 v253, v[212:215] offset:2048
    v_add3_u32 v250, v212, v213, v250
    v_add3_u32 v250, v250, v214, v215
    s_waitcnt vmcnt(4)
    ds_write_b128 v253, v[216:219] offset:3088
    v_add3_u32 v250, v216, v217, v250
    v_add3_u32 v250, v250, v218, v219
    s_waitcnt vmcnt(3)
    ds_write_b128 v253, v[228:231] offset:6176
    v_add3_u32 v251, v228, v229, v251
    v_add3_u32 v251, v251, v230, v231
    s_waitcnt vmcnt(2)
    ds_write_b128 v253, v[232:235] offset:7216
    v_add3_u32 v251, v232, v233, v251
    v_add3_u32 v251, v251, v234, v235
    s_waitcnt vmcnt(1)
    v_sub_u32 v250, v236, v250
    s_waitcnt vmcnt(0)
    v_sub_u32 v251, v238, v251
    v_or_b32 v252, v250, v251
    v_cmp_lt_u32 vcc, 1, v252
    s_nop 0
    s_cbranch_vccnz L_hretry
    ds_write_b32 v102, v252 offset:16
L_hj:
    s_waitcnt lgkmcnt(0)
    s_barrier
    ds_read_b128 v[192:195], v103 offset:28896
    ds_read_b128 v[196:199], v103 offset:24768
    ds_read_b128 v[204:207], v248
    ds_read_b128 v[208:211], v248 offset:16
    s_waitcnt lgkmcnt(3)
    v_mfma_f32_32x32x16_bf16 v[120:135], v[192:195], v[112:115], 0
    ds_read_b128 v[80:83], v105 offset:28896
    ds_read_b128 v[84:87], v105 offset:29936
    s_cmp_lt_u32 s33, 1
    s_cbranch_scc1 L_stub3
L_stubret3:
    s_waitcnt lgkmcnt(3)
    v_or3_b32 v204, v204, v205, v206
    s_waitcnt lgkmcnt(2)
    v_or3_b32 v208, v208, v209, v210
    v_or3_b32 v204, v204, v207, v211
    v_or_b32 v204, v204, v208
    v_cmp_ne_u32 vcc, 0, v204
    s_nop 0
    s_cbranch_vccnz L_fallback
    s_cmp_eq_u32 s33, 0
    s_cselect_b64 vcc, -1, 0
    v_exp_f32 v120, v120
    v_exp_f32 v121, v121
    v_exp_f32 v122, v122
    v_exp_f32 v123, v123
    v_exp_f32 v124, v124
    v_cvt_pk_bf16_f32 v152, v120, v121
    v_exp_f32 v125, v125
    v_exp_f32 v126, v126
    v_cvt_pk_bf16_f32 v153, v122, v123
    v_exp_f32 v127, v127
    v_mfma_f32_32x32x16_bf16 v[136:151], v[196:199], v[112:115], 0
    ds_read_b128 v[200:203], v103 offset:20640
    v_exp_f32 v128, v128
    v_cvt_pk_bf16_f32 v154, v124, v125
    v_exp_f32 v129, v129
    v_exp_f32 v130, v130
    v_cvt_pk_bf16_f32 v155, v126, v127
    v_exp_f32 v131, v131
    v_exp_f32 v132, v132
    v_cvt_pk_bf16_f32 v156, v128, v129
    v_exp_f32 v133, v133
    v_exp_f32 v134, v134
    v_cvt_pk_bf16_f32 v157, v130, v131
    v_exp_f32 v135, v135
    v_cvt_pk_bf16_f32 v158, v132, v133
    v_cvt_pk_bf16_f32 v159, v134, v135
    s_waitcnt lgkmcnt(0)
    v_mfma_f32_32x32x16_bf16 v[160:175], v[80:83], v[152:155], v[160:175]
    v_exp_f32 v136, v136
    v_exp_f32 v137, v137
    v_exp_f32 v138, v138
    v_exp_f32 v139, v139
    v_mfma_f32_32x32x16_bf16 v[160:175], v[84:87], v[156:159], v[160:175]
    ds_read_b128 v[80:83], v105 offset:24768
    ds_read_b128 v[84:87], v105 offset:25808
    v_exp_f32 v140, v140
    v_cvt_pk_bf16_f32 v152, v136, v137
    v_exp_f32 v141, v141
    v_exp_f32 v142, v142
    v_cvt_pk_bf16_f32 v153, v138, v139
    v_exp_f32 v143, v143
    v_mfma_f32_32x32x16_bf16 v[120:135], v[200:203], v[112:115], 0
    ds_read_b128 v[192:195], v103 offset:16512
    v_exp_f32 v144, v144
    v_cvt_pk_bf16_f32 v154, v140, v141
    v_exp_f32 v145, v145
    v_exp_f32 v146, v146
    v_cvt_pk_bf16_f32 v155, v142, v143
    v_exp_f32 v147, v147
    v_exp_f32 v148, v148
    v_cvt_pk_bf16_f32 v156, v144, v145
    v_exp_f32 v149, v149
    v_exp_f32 v150, v150
    v_cvt_pk_bf16_f32 v157, v146, v147
    v_exp_f32 v151, v151
    v_cvt_pk_bf16_f32 v158, v148, v149
    v_cvt_pk_bf16_f32 v159, v150, v151
    s_waitcnt lgkmcnt(0)
    v_mfma_f32_32x32x16_bf16 v[160:175], v[80:83], v[152:155], v[160:175]
    v_exp_f32 v120, v120
    v_exp_f32 v121, v121
    v_exp_f32 v122, v122
    v_exp_f32 v123, v123
    v_mfma_f32_32x32x16_bf16 v[160:175], v[84:87], v[156:159], v[160:175]
    ds_read_b128 v[80:83], v105 offset:20640
    ds_read_b128 v[84:87], v105 offset:21680
    v_exp_f32 v124, v124
    v_cvt_pk_bf16_f32 v152, v120, v121
    v_exp_f32 v125, v125
    v_exp_f32 v126, v126
    v_cvt_pk_bf16_f32 v153, v122, v123
    v_exp_f32 v127, v127
    v_mfma_f32_32x32x16_bf16 v[136:151], v[192:195], v[112:115], 0
    ds_read_b128 v[196:199], v103 offset:12384
    v_exp_f32 v128, v128
    v_cvt_pk_bf16_f32 v154, v124, v125
    v_exp_f32 v129, v129
    v_exp_f32 v130, v130
    v_cvt_pk_bf16_f32 v155, v126, v127
    v_exp_f32 v131, v131
    v_exp_f32 v132, v132
    v_cvt_pk_bf16_f32 v156, v128, v129
    v_exp_f32 v133, v133
    v_exp_f32 v134, v134
    v_cvt_pk_bf16_f32 v157, v130, v131
    v_exp_f32 v135, v135
    v_cvt_pk_bf16_f32 v158, v132, v133
    v_cvt_pk_bf16_f32 v159, v134, v135
    s_waitcnt lgkmcnt(0)
    v_mfma_f32_32x32x16_bf16 v[160:175], v[80:83], v[152:155], v[160:175]
    v_exp_f32 v136, v136
    v_exp_f32 v137, v137
    v_exp_f32 v138, v138
    v_exp_f32 v139, v139
    v_mfma_f32_32x32x16_bf16 v[160:175], v[84:87], v[156:159], v[160:175]
    ds_read_b128 v[80:83], v105 offset:16512
    ds_read_b128 v[84:87], v105 offset:17552
    s_add_u32 m0, s66, 131072
    s_mov_b32 s62, 131072
    buffer_load_dwordx4 v5, s[12:15], s62 offen lds
    v_exp_f32 v140, v140
    v_cvt_pk_bf16_f32 v152, v136, v137
    v_exp_f32 v141, v141
    v_exp_f32 v142, v142
    v_cvt_pk_bf16_f32 v153, v138, v139
    v_exp_f32 v143, v143
    v_mfma_f32_32x32x16_bf16 v[120:135], v[196:199], v[112:115], 0
    ds_read_b128 v[200:203], v103 offset:8256
    s_mov_b32 s62, 138240
    buffer_load_dwordx4 v5, s[12:15], s62 offen offset:1024 lds
    v_exp_f32 v144, v144
    v_cvt_pk_bf16_f32 v154, v140, v141
    v_exp_f32 v145, v145
    v_exp_f32 v146, v146
    v_cvt_pk_bf16_f32 v155, v142, v143
    v_exp_f32 v147, v147
    v_exp_f32 v148, v148
    v_cvt_pk_bf16_f32 v156, v144, v145
    v_exp_f32 v149, v149
    v_exp_f32 v150, v150
    v_cvt_pk_bf16_f32 v157, v146, v147
    v_exp_f32 v151, v151
    v_cvt_pk_bf16_f32 v158, v148, v149
    v_cvt_pk_bf16_f32 v159, v150, v151
    s_waitcnt lgkmcnt(0)
    v_mfma_f32_32x32x16_bf16 v[160:175], v[80:83], v[152:155], v[160:175]
    v_exp_f32 v120, v120
    v_exp_f32 v121, v121
    v_exp_f32 v122, v122
    v_exp_f32 v123, v123
    v_mfma_f32_32x32x16_bf16 v[160:175], v[84:87], v[156:159], v[160:175]
    ds_read_b128 v[80:83], v105 offset:12384
    ds_read_b128 v[84:87], v105 offset:13424
    s_add_u32 m0, s66, 133120
    s_mov_b32 s62, 147456
    buffer_load_dwordx4 v5, s[12:15], s62 offen lds
    v_exp_f32 v124, v124
    v_cvt_pk_bf16_f32 v152, v120, v121
    v_exp_f32 v125, v125
    v_exp_f32 v126, v126
    v_cvt_pk_bf16_f32 v153, v122, v123
    v_exp_f32 v127, v127
    v_mfma_f32_32x32x16_bf16 v[136:151], v[200:203], v[112:115], 0
    ds_read_b128 v[192:195], v103 offset:4128
    s_mov_b32 s62, 154624
    buffer_load_dwordx4 v5, s[12:15], s62 offen offset:1024 lds
    v_exp_f32 v128, v128
    v_cvt_pk_bf16_f32 v154, v124, v125
    v_exp_f32 v129, v129
    v_exp_f32 v130, v130
    v_cvt_pk_bf16_f32 v155, v126, v127
    v_exp_f32 v131, v131
    v_exp_f32 v132, v132
    v_cvt_pk_bf16_f32 v156, v128, v129
    v_exp_f32 v133, v133
    v_exp_f32 v134, v134
    v_cvt_pk_bf16_f32 v157, v130, v131
    v_exp_f32 v135, v135
    v_cvt_pk_bf16_f32 v158, v132, v133
    v_cvt_pk_bf16_f32 v159, v134, v135
    s_waitcnt lgkmcnt(0)
    v_mfma_f32_32x32x16_bf16 v[160:175], v[80:83], v[152:155], v[160:175]
    v_exp_f32 v136, v136
    v_exp_f32 v137, v137
    v_exp_f32 v138, v138
    v_exp_f32 v139, v139
    v_mfma_f32_32x32x16_bf16 v[160:175], v[84:87], v[156:159], v[160:175]
    ds_read_b128 v[80:83], v105 offset:8256
    ds_read_b128 v[84:87], v105 offset:9296
    s_add_u32 m0, s66, 135168
    s_mov_b32 s62, 163840
    buffer_load_dwordx4 v5, s[12:15], s62 offen lds
    v_exp_f32 v140, v140
    v_cvt_pk_bf16_f32 v152, v136, v137
    v_exp_f32 v141, v141
    v_exp_f32 v142, v142
    v_cvt_pk_bf16_f32 v153, v138, v139
    v_exp_f32 v143, v143
    v_mfma_f32_32x32x16_bf16 v[120:135], v[192:195], v[112:115], 0
    ds_read_b128 v[196:199], v103 offset:0
    s_mov_b32 s62, 171008
    buffer_load_dwordx4 v5, s[12:15], s62 offen offset:1024 lds
    v_exp_f32 v144, v144
    v_cvt_pk_bf16_f32 v154, v140, v141
    v_exp_f32 v145, v145
    v_exp_f32 v146, v146
    v_cvt_pk_bf16_f32 v155, v142, v143
    v_exp_f32 v147, v147
    v_exp_f32 v148, v148
    v_cvt_pk_bf16_f32 v156, v144, v145
    v_exp_f32 v149, v149
    v_exp_f32 v150, v150
    v_cvt_pk_bf16_f32 v157, v146, v147
    v_exp_f32 v151, v151
    v_cvt_pk_bf16_f32 v158, v148, v149
    v_cvt_pk_bf16_f32 v159, v150, v151
    s_waitcnt lgkmcnt(0)
    v_mfma_f32_32x32x16_bf16 v[160:175], v[80:83], v[152:155], v[160:175]
    v_exp_f32 v120, v120
    v_exp_f32 v121, v121
    v_exp_f32 v122, v122
    v_exp_f32 v123, v123
    v_mfma_f32_32x32x16_bf16 v[160:175], v[84:87], v[156:159], v[160:175]
    ds_read_b128 v[80:83], v105 offset:4128
    ds_read_b128 v[84:87], v105 offset:5168
    s_add_u32 m0, s66, 137216
    s_mov_b32 s62, 180224
    buffer_load_dwordx4 v5, s[12:15], s62 offen lds
    v_exp_f32 v124, v124
    v_cvt_pk_bf16_f32 v152, v120, v121
    v_exp_f32 v125, v125
    v_exp_f32 v126, v126
    v_cvt_pk_bf16_f32 v153, v122, v123
    v_exp_f32 v127, v127
    v_mfma_f32_32x32x16_bf16 v[136:151], v[196:199], v[112:115], v[48:63]
    ds_read_b128 v[200:203], v104 offset:20640
    s_mov_b32 s62, 187392
    buffer_load_dwordx4 v5, s[12:15], s62 offen offset:1024 lds
    v_exp_f32 v128, v128
    v_cvt_pk_bf16_f32 v154, v124, v125
    v_exp_f32 v129, v129
    v_exp_f32 v130, v130
    v_cvt_pk_bf16_f32 v155, v126, v127
    v_exp_f32 v131, v131
    v_exp_f32 v132, v132
    v_cvt_pk_bf16_f32 v156, v128, v129
    v_exp_f32 v133, v133
    v_exp_f32 v134, v134
    v_cvt_pk_bf16_f32 v157, v130, v131
    v_exp_f32 v135, v135
    v_cvt_pk_bf16_f32 v158, v132, v133
    v_cvt_pk_bf16_f32 v159, v134, v135
    s_waitcnt lgkmcnt(0)
    v_mfma_f32_32x32x16_bf16 v[160:175], v[80:83], v[152:155], v[160:175]
    v_exp_f32 v136, v136
    v_exp_f32 v137, v137
    v_exp_f32 v138, v138
    v_exp_f32 v139, v139
    v_mfma_f32_32x32x16_bf16 v[160:175], v[84:87], v[156:159], v[160:175]
    ds_read_b128 v[80:83], v105 offset:0
    ds_read_b128 v[84:87], v105 offset:1040
    v_exp_f32 v140, v140
    v_cvt_pk_bf16_f32 v152, v136, v137
    v_exp_f32 v141, v141
    v_exp_f32 v142, v142
    v_cvt_pk_bf16_f32 v153, v138, v139
    v_exp_f32 v143, v143
    v_mfma_f32_32x32x16_bf16 v[120:135], v[200:203], v[116:119], 0
    ds_read_b128 v[192:195], v104 offset:16512
    v_exp_f32 v144, v144
    v_cvt_pk_bf16_f32 v154, v140, v141
    v_exp_f32 v145, v145
    v_exp_f32 v146, v146
    v_cvt_pk_bf16_f32 v155, v142, v143
    v_exp_f32 v147, v147
    v_exp_f32 v148, v148
    v_cvt_pk_bf16_f32 v156, v144, v145
    v_exp_f32 v149, v149
    v_exp_f32 v150, v150
    v_cvt_pk_bf16_f32 v157, v146, v147
    v_exp_f32 v151, v151
    v_cvt_pk_bf16_f32 v158, v148, v149
    v_cvt_pk_bf16_f32 v159, v150, v151
    s_waitcnt lgkmcnt(0)
    v_mfma_f32_32x32x16_bf16 v[160:175], v[80:83], v[152:155], v[160:175]
    v_exp_f32 v120, v120
    v_exp_f32 v121, v121
    v_exp_f32 v122, v122
    v_exp_f32 v123, v123
    v_mfma_f32_32x32x16_bf16 v[160:175], v[84:87], v[156:159], v[160:175]
    ds_read_b128 v[88:91], v106 offset:20640
    ds_read_b128 v[92:95], v106 offset:21680
    v_exp_f32 v124, v124
    v_cvt_pk_bf16_f32 v152, v120, v121
    v_exp_f32 v125, v125
    v_exp_f32 v126, v126
    v_cvt_pk_bf16_f32 v153, v122, v123
    v_exp_f32 v127, v127
    v_mfma_f32_32x32x16_bf16 v[136:151], v[192:195], v[116:119], 0
    ds_read_b128 v[196:199], v104 offset:12384
    v_exp_f32 v128, v128
    v_cvt_pk_bf16_f32 v154, v124, v125
    v_exp_f32 v129, v129
    v_exp_f32 v130, v130
    v_cvt_pk_bf16_f32 v155, v126, v127
    v_exp_f32 v131, v131
    v_exp_f32 v132, v132
    v_cvt_pk_bf16_f32 v156, v128, v129
    v_exp_f32 v133, v133
    v_exp_f32 v134, v134
    v_cvt_pk_bf16_f32 v157, v130, v131
    v_exp_f32 v135, v135
    v_cvt_pk_bf16_f32 v158, v132, v133
    v_cvt_pk_bf16_f32 v159, v134, v135
    s_waitcnt lgkmcnt(0)
    v_mfma_f32_32x32x16_bf16 v[176:191], v[88:91], v[152:155], v[176:191]
    s_cbranch_vccnz L_stub4
L_stubret4:
    v_exp_f32 v136, v136
    v_exp_f32 v137, v137
    v_exp_f32 v138, v138
    v_exp_f32 v139, v139
    v_mfma_f32_32x32x16_bf16 v[176:191], v[92:95], v[156:159], v[176:191]
    ds_read_b128 v[88:91], v106 offset:16512
    ds_read_b128 v[92:95], v106 offset:17552
    v_exp_f32 v140, v140
    v_cvt_pk_bf16_f32 v152, v136, v137
    v_exp_f32 v141, v141
    v_exp_f32 v142, v142
    v_cvt_pk_bf16_f32 v153, v138, v139
    v_exp_f32 v143, v143
    v_mfma_f32_32x32x16_bf16 v[120:135], v[196:199], v[116:119], 0
    ds_read_b128 v[200:203], v104 offset:8256
    v_exp_f32 v144, v144
    v_cvt_pk_bf16_f32 v154, v140, v141
    v_exp_f32 v145, v145
    v_exp_f32 v146, v146
    v_cvt_pk_bf16_f32 v155, v142, v143
    v_exp_f32 v147, v147
    v_exp_f32 v148, v148
    v_cvt_pk_bf16_f32 v156, v144, v145
    v_exp_f32 v149, v149
    v_exp_f32 v150, v150
    v_cvt_pk_bf16_f32 v157, v146, v147
    v_exp_f32 v151, v151
    v_cvt_pk_bf16_f32 v158, v148, v149
    v_cvt_pk_bf16_f32 v159, v150, v151
    s_waitcnt lgkmcnt(0)
    v_mfma_f32_32x32x16_bf16 v[176:191], v[88:91], v[152:155], v[176:191]
    v_exp_f32 v120, v120
    v_exp_f32 v121, v121
    v_exp_f32 v122, v122
    v_exp_f32 v123, v123
    v_mfma_f32_32x32x16_bf16 v[176:191], v[92:95], v[156:159], v[176:191]
    ds_read_b128 v[88:91], v106 offset:12384
    ds_read_b128 v[92:95], v106 offset:13424
    v_exp_f32 v124, v124
    v_cvt_pk_bf16_f32 v152, v120, v121
    v_exp_f32 v125, v125
    v_exp_f32 v126, v126
    v_cvt_pk_bf16_f32 v153, v122, v123
    v_exp_f32 v127, v127
    v_mfma_f32_32x32x16_bf16 v[136:151], v[200:203], v[116:119], 0
    ds_read_b128 v[192:195], v104 offset:4128
    v_exp_f32 v128, v128
    v_cvt_pk_bf16_f32 v154, v124, v125
    v_exp_f32 v129, v129
    v_exp_f32 v130, v130
    v_cvt_pk_bf16_f32 v155, v126, v127
    v_exp_f32 v131, v131
    v_exp_f32 v132, v132
    v_cvt_pk_bf16_f32 v156, v128, v129
    v_exp_f32 v133, v133
    v_exp_f32 v134, v134
    v_cvt_pk_bf16_f32 v157, v130, v131
    v_exp_f32 v135, v135
    v_cvt_pk_bf16_f32 v158, v132, v133
    v_cvt_pk_bf16_f32 v159, v134, v135
    s_waitcnt lgkmcnt(0)
    v_mfma_f32_32x32x16_bf16 v[176:191], v[88:91], v[152:155], v[176:191]
    s_cbranch_vccnz L_stub5
L_stubret5:
    v_exp_f32 v136, v136
    v_exp_f32 v137, v137
    v_exp_f32 v138, v138
    v_exp_f32 v139, v139
    v_mfma_f32_32x32x16_bf16 v[176:191], v[92:95], v[156:159], v[176:191]
    ds_read_b128 v[88:91], v106 offset:8256
    ds_read_b128 v[92:95], v106 offset:9296
    v_exp_f32 v140, v140
    v_cvt_pk_bf16_f32 v152, v136, v137
    v_exp_f32 v141, v141
    v_exp_f32 v142, v142
    v_cvt_pk_bf16_f32 v153, v138, v139
    v_exp_f32 v143, v143
    v_mfma_f32_32x32x16_bf16 v[120:135], v[192:195], v[116:119], 0
    ds_read_b128 v[196:199], v104 offset:0
    v_exp_f32 v144, v144
    v_cvt_pk_bf16_f32 v154, v140, v141
    v_exp_f32 v145, v145
    v_exp_f32 v146, v146
    v_cvt_pk_bf16_f32 v155, v142, v143
    v_exp_f32 v147, v147
    v_exp_f32 v148, v148
    v_cvt_pk_bf16_f32 v156, v144, v145
    v_exp_f32 v149, v149
    v_exp_f32 v150, v150
    v_cvt_pk_bf16_f32 v157, v146, v147
    v_exp_f32 v151, v151
    v_cvt_pk_bf16_f32 v158, v148, v149
    v_cvt_pk_bf16_f32 v159, v150, v151
    s_waitcnt lgkmcnt(0)
    v_mfma_f32_32x32x16_bf16 v[176:191], v[88:91], v[152:155], v[176:191]
    v_exp_f32 v120, v120
    v_exp_f32 v121, v121
    v_exp_f32 v122, v122
    v_exp_f32 v123, v123
    v_mfma_f32_32x32x16_bf16 v[176:191], v[92:95], v[156:159], v[176:191]
    ds_read_b128 v[88:91], v106 offset:4128
    ds_read_b128 v[92:95], v106 offset:5168
    v_exp_f32 v124, v124
    v_cvt_pk_bf16_f32 v152, v120, v121
    v_exp_f32 v125, v125
    v_exp_f32 v126, v126
    v_cvt_pk_bf16_f32 v153, v122, v123
    v_exp_f32 v127, v127
    v_mfma_f32_32x32x16_bf16 v[136:151], v[196:199], v[116:119], v[48:63]
    v_exp_f32 v128, v128
    v_cvt_pk_bf16_f32 v154, v124, v125
    v_exp_f32 v129, v129
    v_exp_f32 v130, v130
    v_cvt_pk_bf16_f32 v155, v126, v127
    v_exp_f32 v131, v131
    v_exp_f32 v132, v132
    v_cvt_pk_bf16_f32 v156, v128, v129
    v_exp_f32 v133, v133
    v_exp_f32 v134, v134
    v_cvt_pk_bf16_f32 v157, v130, v131
    v_exp_f32 v135, v135
    v_cvt_pk_bf16_f32 v158, v132, v133
    v_cvt_pk_bf16_f32 v159, v134, v135
    s_waitcnt lgkmcnt(0)
    v_mfma_f32_32x32x16_bf16 v[176:191], v[88:91], v[152:155], v[176:191]
    s_cbranch_vccnz L_stub6
L_stubret6:
    v_exp_f32 v136, v136
    v_exp_f32 v137, v137
    v_exp_f32 v138, v138
    v_exp_f32 v139, v139
    v_mfma_f32_32x32x16_bf16 v[176:191], v[92:95], v[156:159], v[176:191]
    ds_read_b128 v[88:91], v106 offset:0
    ds_read_b128 v[92:95], v106 offset:1040
    v_exp_f32 v140, v140
    v_cvt_pk_bf16_f32 v152, v136, v137
    v_exp_f32 v141, v141
    v_exp_f32 v142, v142
    v_cvt_pk_bf16_f32 v153, v138, v139
    v_exp_f32 v143, v143
    v_exp_f32 v144, v144
    v_cvt_pk_bf16_f32 v154, v140, v141
    v_exp_f32 v145, v145
    v_exp_f32 v146, v146
    v_cvt_pk_bf16_f32 v155, v142, v143
    v_exp_f32 v147, v147
    v_exp_f32 v148, v148
    s_waitcnt lgkmcnt(1)
    v_mfma_f32_32x32x16_bf16 v[176:191], v[88:91], v[152:155], v[176:191]
    v_cvt_pk_bf16_f32 v156, v144, v145
    v_exp_f32 v149, v149
    v_exp_f32 v150, v150
    v_cvt_pk_bf16_f32 v157, v146, v147
    v_exp_f32 v151, v151
    v_cvt_pk_bf16_f32 v158, v148, v149
    v_cvt_pk_bf16_f32 v159, v150, v151
    s_waitcnt lgkmcnt(0)
    s_nop 0
    v_mfma_f32_32x32x16_bf16 v[176:191], v[92:95], v[156:159], v[176:191]
    v_rcp_f32 v168, v168
    s_nop 0
    v_mul_f32 v160, v160, v168
    v_mul_f32 v161, v161, v168
    v_mul_f32 v162, v162, v168
    v_mul_f32 v163, v163, v168
    v_mul_f32 v164, v164, v168
    v_mul_f32 v165, v165, v168
    v_mul_f32 v166, v166, v168
    v_mul_f32 v167, v167, v168
    v_cvt_pk_bf16_f32 v240, v160, v161
    v_cvt_pk_bf16_f32 v241, v162, v163
    v_cvt_pk_bf16_f32 v242, v164, v165
    v_cvt_pk_bf16_f32 v243, v166, v167
    v_rcp_f32 v184, v184
    s_nop 0
    v_pk_mul_f32 v[176:177], v[176:177], v[184:185] op_sel:[0,0] op_sel_hi:[1,0]
    v_pk_mul_f32 v[178:179], v[178:179], v[184:185] op_sel:[0,0] op_sel_hi:[1,0]
    v_pk_mul_f32 v[180:181], v[180:181], v[184:185] op_sel:[0,0] op_sel_hi:[1,0]
    v_pk_mul_f32 v[182:183], v[182:183], v[184:185] op_sel:[0,0] op_sel_hi:[1,0]
    v_cvt_pk_bf16_f32 v244, v176, v177
    v_cvt_pk_bf16_f32 v245, v178, v179
    v_cvt_pk_bf16_f32 v246, v180, v181
    v_cvt_pk_bf16_f32 v247, v182, v183
L_opubA:
    s_cmp_eq_u32 s33, 0
    s_cbranch_scc1 L_opubA0
L_opubA2:
    s_cmp_eq_u32 s34, 0
    s_cbranch_scc1 L_opubsA2_slow
    buffer_store_dwordx4 v[240:243], v1, s[16:19], s46 offen
    buffer_store_dwordx4 v[244:247], v1, s[16:19], s47 offen
    ds_write_b128 v12, a[192:195] offset:32768
    ds_write_b128 v12, a[196:199] offset:33792
    ds_write_b128 v12, a[200:203] offset:34816
    ds_write_b128 v12, a[204:207] offset:35840
    ds_write_b128 v12, a[208:211] offset:36864
    ds_write_b128 v12, a[212:215] offset:37888
    s_lshr_b32 s63, s30, 1
    s_lshl_b32 s62, s63, 6
    s_add_u32 s69, s24, s35
    s_add_u32 s67, s69, s62
    s_add_u32 s67, s67, 74752
    s_lshl_b32 s63, s63, 14
    s_add_u32 s61, s36, s35
    s_add_u32 s68, s61, s63
    s_add_u32 s68, s68, 32768
    s_mov_b64 exec, 1
    s_waitcnt vmcnt(0)
    buffer_store_dword v96, v111, s[16:19], s38 offen
    buffer_store_dword v96, v111, s[16:19], s25 offen
    s_mov_b64 exec, -1
L_opubsA2_join:
    s_barrier
    buffer_load_dword v249, v110, s[16:19], s67 offen sc1
    s_mov_b32 s39, 0
    ds_write_b128 v12, a[216:219] offset:38912
    ds_write_b128 v12, a[220:223] offset:39936
    buffer_load_dword v250, v110, s[16:19], s67 offen sc1
    ds_write_b128 v13, a[224:227] offset:0
    ds_write_b128 v13, a[228:231] offset:1024
L_poll_6:
    s_waitcnt vmcnt(1)
    v_cmp_ne_u32 vcc, s32, v249
    s_nop 0
    s_cbranch_vccz L_polldone_7
    buffer_load_dword v249, v110, s[16:19], s67 offen sc1
    s_waitcnt vmcnt(1)
    v_cmp_ne_u32 vcc, s32, v250
    s_nop 0
    s_cbranch_vccz L_polldone_7
    buffer_load_dword v250, v110, s[16:19], s67 offen sc1
    s_add_u32 s39, s39, 1
    s_cmp_lt_u32 s39, 1048576
    s_cbranch_scc1 L_poll_6
    s_branch L_end
L_polldone_7:
    buffer_load_dwordx4 a[64:67], v1, s[16:19], s68 offen offset:0 sc1
    buffer_load_dwordx4 a[68:71], v1, s[16:19], s68 offen offset:1024 sc1
    buffer_load_dwordx4 a[72:75], v1, s[16:19], s68 offen offset:2048 sc1
    v_mov_b32 v80, 0x3f803f80
    v_mov_b32 v81, 0x3f803f80
    v_mov_b32 v82, 0x3f803f80
    v_mov_b32 v83, 0x3f803f80
    s_add_u32 s38, s38, 0x100
    s_add_u32 s25, s25, 0x100
    s_mov_b32 s12, s52
    s_mov_b32 s13, s53
    s_add_u32 s24, s24, 0x80
    s_add_u32 s67, s24, 73728
    s_bfe_u32 s62, s57, 0x60009
    s_add_u32 s62, s62, s69
    s_add_u32 s62, s62, 73856
    v_xor_b32 v8, 0x200, v8
    v_xor_b32 v9, 0x200, v9
    v_xor_b32 v248, 0x2000, v100
    s_mov_b32 s37, 0x3fb8aa3b
    s_mov_b32 s56, 0x3fb8aa3b
    buffer_load_dwordx4 a[76:79], v1, s[16:19], s68 offen offset:3072 sc1
    s_add_u32 s66, s68, 4096
    ds_write_b128 v13, a[232:235] offset:2048
    buffer_load_dwordx4 a[80:83], v1, s[16:19], s66 offen offset:0 sc1
    ds_write_b128 v13, a[236:239] offset:3072
    buffer_load_dwordx4 a[84:87], v1, s[16:19], s66 offen offset:1024 sc1
    ds_write_b128 v13, a[240:243] offset:4096
    buffer_load_dwordx4 a[88:91], v1, s[16:19], s66 offen offset:2048 sc1
    ds_write_b128 v13, a[244:247] offset:5120
    ds_write_b128 v13, a[248:251] offset:6144
    ds_write_b128 v13, a[252:255] offset:7168
    s_waitcnt vmcnt(6)
    v_mfma_f32_32x32x16_bf16 v[224:239], a[0:3], a[64:67], 0
    buffer_load_dwordx4 a[92:95], v1, s[16:19], s66 offen offset:3072 sc1
    s_add_u32 s66, s66, 4096
    v_mfma_f32_32x32x16_bf16 v[16:31], a[4:7], a[64:67], v[16:31]
    s_waitcnt vmcnt(6)
    v_mfma_f32_32x32x16_bf16 v[224:239], a[8:11], a[68:71], v[224:239]
    buffer_load_dwordx4 a[96:99], v1, s[16:19], s66 offen offset:0 sc1
    v_mfma_f32_32x32x16_bf16 v[16:31], a[12:15], a[68:71], v[16:31]
    s_waitcnt vmcnt(6)
    v_mfma_f32_32x32x16_bf16 v[224:239], a[16:19], a[72:75], v[224:239]
    buffer_load_dwordx4 a[100:103], v1, s[16:19], s66 offen offset:1024 sc1
    v_mfma_f32_32x32x16_bf16 v[16:31], a[20:23], a[72:75], v[16:31]
    s_waitcnt vmcnt(6)
    v_mfma_f32_32x32x16_bf16 v[224:239], a[24:27], a[76:79], v[224:239]
    buffer_load_dwordx4 a[104:107], v1, s[16:19], s66 offen offset:2048 sc1
    v_mfma_f32_32x32x16_bf16 v[16:31], a[28:31], a[76:79], v[16:31]
    s_waitcnt vmcnt(6)
    v_mfma_f32_32x32x16_bf16 v[224:239], a[32:35], a[80:83], v[224:239]
    buffer_load_dwordx4 a[108:111], v1, s[16:19], s66 offen offset:3072 sc1
    s_add_u32 s66, s66, 4096
    v_mfma_f32_32x32x16_bf16 v[16:31], a[36:39], a[80:83], v[16:31]
    s_waitcnt vmcnt(6)
    v_mfma_f32_32x32x16_bf16 v[224:239], a[40:43], a[84:87], v[224:239]
    buffer_load_dwordx4 a[112:115], v1, s[16:19], s66 offen offset:0 sc1
    v_mfma_f32_32x32x16_bf16 v[16:31], a[44:47], a[84:87], v[16:31]
    s_waitcnt vmcnt(6)
    v_mfma_f32_32x32x16_bf16 v[224:239], a[48:51], a[88:91], v[224:239]
    ds_read_b64_tr_b16 v[176:177], v109 offset:0
    ds_read_b64_tr_b16 v[178:179], v109 offset:1024
    buffer_load_dwordx4 a[116:119], v1, s[16:19], s66 offen offset:1024 sc1
    v_mfma_f32_32x32x16_bf16 v[16:31], a[52:55], a[88:91], v[16:31]
    ds_read_b64_tr_b16 v[180:181], v98 offset:0
    ds_read_b64_tr_b16 v[182:183], v98 offset:1024
    s_waitcnt vmcnt(6)
    v_mfma_f32_32x32x16_bf16 v[224:239], a[56:59], a[92:95], v[224:239]
    ds_read_b64_tr_b16 v[160:161], v109 offset:2048
    ds_read_b64_tr_b16 v[162:163], v109 offset:3072
    buffer_load_dwordx4 a[120:123], v1, s[16:19], s66 offen offset:2048 sc1
    v_mfma_f32_32x32x16_bf16 v[16:31], a[60:63], a[92:95], v[16:31]
    ds_read_b64_tr_b16 v[164:165], v98 offset:2048
    ds_read_b64_tr_b16 v[166:167], v98 offset:3072
    s_waitcnt vmcnt(6) lgkmcnt(6)
    v_mfma_f32_32x32x16_bf16 v[224:239], v[176:179], a[96:99], v[224:239]
    ds_read_b64_tr_b16 v[168:169], v109 offset:4096
    ds_read_b64_tr_b16 v[170:171], v109 offset:5120
    buffer_load_dwordx4 a[124:127], v1, s[16:19], s66 offen offset:3072 sc1
    s_add_u32 s66, s66, 4096
    s_waitcnt lgkmcnt(6)
    v_mfma_f32_32x32x16_bf16 v[16:31], v[180:183], a[96:99], v[16:31]
    ds_read_b64_tr_b16 v[172:173], v98 offset:4096
    ds_read_b64_tr_b16 v[174:175], v98 offset:5120
    s_waitcnt vmcnt(6) lgkmcnt(6)
    v_mfma_f32_32x32x16_bf16 v[224:239], v[160:163], a[100:103], v[224:239]
    ds_read_b64_tr_b16 v[176:177], v109 offset:6144
    ds_read_b64_tr_b16 v[178:179], v109 offset:7168
    s_waitcnt lgkmcnt(6)
    v_mfma_f32_32x32x16_bf16 v[16:31], v[164:167], a[100:103], v[16:31]
    ds_read_b64_tr_b16 v[180:181], v98 offset:6144
    ds_read_b64_tr_b16 v[182:183], v98 offset:7168
    s_waitcnt vmcnt(5) lgkmcnt(6)
    v_mfma_f32_32x32x16_bf16 v[224:239], v[168:171], a[104:107], v[224:239]
    ds_read_b64_tr_b16 v[160:161], v109 offset:8192
    ds_read_b64_tr_b16 v[162:163], v109 offset:9216
    s_waitcnt lgkmcnt(6)
    v_mfma_f32_32x32x16_bf16 v[16:31], v[172:175], a[104:107], v[16:31]
    ds_read_b64_tr_b16 v[164:165], v109 offset:10240
    ds_read_b64_tr_b16 v[166:167], v109 offset:11264
    s_waitcnt vmcnt(4) lgkmcnt(6)
    v_mfma_f32_32x32x16_bf16 v[224:239], v[176:179], a[108:111], v[224:239]
    ds_read_b64_tr_b16 v[168:169], v109 offset:12288
    ds_read_b64_tr_b16 v[170:171], v109 offset:13312
    s_waitcnt lgkmcnt(6)
    v_mfma_f32_32x32x16_bf16 v[16:31], v[180:183], a[108:111], v[16:31]
    ds_read_b64_tr_b16 v[172:173], v109 offset:14336
    ds_read_b64_tr_b16 v[174:175], v109 offset:15360
    s_waitcnt vmcnt(3) lgkmcnt(6)
    v_mfma_f32_32x32x16_bf16 v[224:239], v[160:163], a[112:115], v[224:239]
    ds_read_b64_tr_b16 v[176:177], v98 offset:8192
    ds_read_b64_tr_b16 v[178:179], v98 offset:9216
    s_waitcnt vmcnt(2) lgkmcnt(6)
    v_mfma_f32_32x32x16_bf16 v[224:239], v[164:167], a[116:119], v[224:239]
    ds_read_b64_tr_b16 v[180:181], v98 offset:10240
    ds_read_b64_tr_b16 v[182:183], v98 offset:11264
    s_waitcnt vmcnt(1) lgkmcnt(6)
    v_mfma_f32_32x32x16_bf16 v[224:239], v[168:171], a[120:123], v[224:239]
    ds_read_b64_tr_b16 v[160:161], v98 offset:12288
    ds_read_b64_tr_b16 v[162:163], v98 offset:13312
    s_waitcnt vmcnt(0) lgkmcnt(6)
    v_mfma_f32_32x32x16_bf16 v[224:239], v[172:175], a[124:127], v[224:239]
    ds_read_b64_tr_b16 v[164:165], v98 offset:14336
    ds_read_b64_tr_b16 v[166:167], v98 offset:15360
    s_waitcnt lgkmcnt(6)
    v_mfma_f32_32x32x16_bf16 v[16:31], v[176:179], a[112:115], v[16:31]
    s_waitcnt lgkmcnt(4)
    v_mfma_f32_32x32x16_bf16 v[16:31], v[180:183], a[116:119], v[16:31]
    s_nop 5
    ds_write_b128 v248, v[224:227] offset:0
    ds_write_b128 v248, v[228:231] offset:1024
    s_waitcnt lgkmcnt(4)
    v_mfma_f32_32x32x16_bf16 v[16:31], v[160:163], a[120:123], v[16:31]
    ds_write_b128 v248, v[232:235] offset:2048
    s_waitcnt lgkmcnt(3)
    v_mfma_f32_32x32x16_bf16 v[16:31], v[164:167], a[124:127], v[16:31]
    ds_write_b128 v248, v[236:239] offset:3072
    s_waitcnt lgkmcnt(0)
    s_barrier
    ds_read_b128 v[224:227], v100 offset:0
    ds_read_b128 v[228:231], v100 offset:1024
    ds_read_b128 v[232:235], v100 offset:2048
    ds_read_b128 v[236:239], v100 offset:3072
    s_waitcnt lgkmcnt(3)
    s_nop 3
    v_pk_add_f32 v[16:17], v[16:17], v[224:225]
    v_pk_add_f32 v[18:19], v[18:19], v[226:227]
    v_cvt_pk_bf16_f32 v240, v16, v17
    v_cvt_pk_bf16_f32 v241, v18, v19
    s_waitcnt lgkmcnt(2)
    v_pk_add_f32 v[20:21], v[20:21], v[228:229]
    v_pk_add_f32 v[22:23], v[22:23], v[230:231]
    v_cvt_pk_bf16_f32 v242, v20, v21
    v_cvt_pk_bf16_f32 v243, v22, v23
    s_waitcnt lgkmcnt(1)
    v_pk_add_f32 v[24:25], v[24:25], v[232:233]
    v_pk_add_f32 v[26:27], v[26:27], v[234:235]
    v_cvt_pk_bf16_f32 v244, v24, v25
    v_cvt_pk_bf16_f32 v245, v26, v27
    s_waitcnt lgkmcnt(0)
    v_pk_add_f32 v[28:29], v[28:29], v[236:237]
    v_pk_add_f32 v[30:31], v[30:31], v[238:239]
    v_cvt_pk_bf16_f32 v246, v28, v29
    v_cvt_pk_bf16_f32 v247, v30, v31
    s_cmp_eq_u32 s34, 0
    s_cbranch_scc1 L_xpubsA2_slow
    buffer_store_dwordx4 v[240:243], v1, s[16:19], s57 offen
    buffer_store_dwordx4 v[244:247], v1, s[16:19], s57 offen offset:1024
    v_pk_add_f32 v[116:117], v[16:17], v[18:19]
    v_pk_mul_f32 v[118:119], v[16:17], v[16:17]
    v_pk_fma_f32 v[118:119], v[18:19], v[18:19], v[118:119]
    v_pk_add_f32 v[116:117], v[116:117], v[20:21]
    v_pk_fma_f32 v[118:119], v[20:21], v[20:21], v[118:119]
    v_pk_add_f32 v[116:117], v[116:117], v[22:23]
    v_pk_fma_f32 v[118:119], v[22:23], v[22:23], v[118:119]
    v_pk_add_f32 v[116:117], v[116:117], v[24:25]
    v_pk_fma_f32 v[118:119], v[24:25], v[24:25], v[118:119]
    v_pk_add_f32 v[116:117], v[116:117], v[26:27]
    v_pk_fma_f32 v[118:119], v[26:27], v[26:27], v[118:119]
    v_pk_add_f32 v[116:117], v[116:117], v[28:29]
    v_pk_fma_f32 v[118:119], v[28:29], v[28:29], v[118:119]
    v_pk_add_f32 v[116:117], v[116:117], v[30:31]
    v_pk_fma_f32 v[118:119], v[30:31], v[30:31], v[118:119]
    v_add_f32 v116, v116, v117
    v_add_f32 v118, v118, v119
    s_nop 1
    v_permlane32_swap_b32 v116, v118
    v_add_f32 v116, v116, v118
    v_and_or_b32 v116, v116, -16, 8
    buffer_store_dword v116, v7, s[16:19], s61 offen
    ds_write_b128 v12, a[160:163] offset:0
    ds_write_b128 v12, a[164:167] offset:1024
    ds_write_b128 v12, a[168:171] offset:2048
    s_mov_b64 exec, 1
    s_waitcnt vmcnt(1)
    buffer_store_dword v96, v111, s[16:19], s62 offen
    s_mov_b64 exec, -1
L_xpubsA2_join:
    ds_write_b128 v12, a[172:175] offset:3072
    ds_write_b128 v12, a[176:179] offset:4096
    ds_write_b128 v12, a[180:183] offset:5120
    ds_write_b128 v12, a[184:187] offset:6144
    ds_write_b128 v12, a[188:191] offset:7168
    s_add_u32 s33, s33, 1
    s_branch L_layer
L_opubA0:
    s_cmp_eq_u32 s34, 0
    s_cbranch_scc1 L_opubsA0_slow
    buffer_store_dwordx4 v[240:243], v1, s[16:19], s46 offen
    buffer_store_dwordx4 v[244:247], v1, s[16:19], s47 offen
    s_lshl_b32 s63, s30, 13
    s_sub_u32 s63, s63, 131072
    v_add_u32 v220, s63, v4
    v_add_u32 v221, 0x10000, v220
    v_lshrrev_b32 v216, 4, v0
    v_xor_b32 v216, v216, v0
    v_and_b32 v216, 1, v216
    v_add_u32 v216, -1, v216
    v_and_b32 v216, 0x3f803f80, v216
    v_mov_b32 v217, v216
    v_mov_b32 v218, v216
    v_mov_b32 v219, v216
    s_waitcnt vmcnt(2)
    ds_read_b64_tr_b16 v[184:185], v220 offset:32768
    ds_read_b64_tr_b16 v[186:187], v220 offset:33280
    ds_read_b64_tr_b16 v[188:189], v220 offset:33792
    ds_read_b64_tr_b16 v[190:191], v220 offset:34304
    ds_read_b64_tr_b16 v[192:193], v220 offset:34816
    ds_read_b64_tr_b16 v[194:195], v220 offset:35328
    s_waitcnt lgkmcnt(4)
    v_mfma_f32_16x16x32_bf16 v[112:115], v[216:219], v[184:187], 0
    ds_write_b128 v12, v[184:187] offset:32768
    ds_read_b64_tr_b16 v[196:197], v220 offset:35840
    ds_read_b64_tr_b16 v[198:199], v220 offset:36352
    s_waitcnt lgkmcnt(5)
    v_mfma_f32_16x16x32_bf16 v[112:115], v[216:219], v[188:191], v[112:115]
    ds_write_b128 v12, v[188:191] offset:33792
    s_lshr_b32 s63, s30, 1
    s_lshl_b32 s62, s63, 6
    s_add_u32 s69, s24, s35
    s_add_u32 s67, s69, s62
    s_add_u32 s67, s67, 74752
    s_lshl_b32 s63, s63, 14
    s_add_u32 s61, s36, s35
    s_add_u32 s68, s61, s63
    s_add_u32 s68, s68, 32768
    s_mov_b64 exec, 1
    s_waitcnt vmcnt(0)
    buffer_store_dword v96, v111, s[16:19], s38 offen
    buffer_store_dword v96, v111, s[16:19], s25 offen
    s_mov_b64 exec, -1
L_opubsA0_join:
    s_barrier
    buffer_load_dword v249, v110, s[16:19], s67 offen sc1
    s_mov_b32 s39, 0
    ds_read_b64_tr_b16 v[200:201], v220 offset:36864
    ds_read_b64_tr_b16 v[202:203], v220 offset:37376
    buffer_load_dword v250, v110, s[16:19], s67 offen sc1
    s_waitcnt lgkmcnt(6)
    v_mfma_f32_16x16x32_bf16 v[112:115], v[216:219], v[192:195], v[112:115]
    ds_write_b128 v12, v[192:195] offset:34816
    ds_read_b64_tr_b16 v[204:205], v220 offset:37888
    ds_read_b64_tr_b16 v[206:207], v220 offset:38400
    s_waitcnt lgkmcnt(6)
    v_mfma_f32_16x16x32_bf16 v[112:115], v[216:219], v[196:199], v[112:115]
    ds_write_b128 v12, v[196:199] offset:35840
    ds_read_b64_tr_b16 v[208:209], v220 offset:38912
    ds_read_b64_tr_b16 v[210:211], v220 offset:39424
    s_waitcnt lgkmcnt(6)
    v_mfma_f32_16x16x32_bf16 v[112:115], v[216:219], v[200:203], v[112:115]
    ds_write_b128 v12, v[200:203] offset:36864
    ds_read_b64_tr_b16 v[212:213], v220 offset:39936
    ds_read_b64_tr_b16 v[214:215], v220 offset:40448
    s_waitcnt lgkmcnt(6)
    v_mfma_f32_16x16x32_bf16 v[112:115], v[216:219], v[204:207], v[112:115]
    ds_write_b128 v12, v[204:207] offset:37888
    ds_write_b128 v13, a[224:227] offset:0
    ds_write_b128 v13, a[228:231] offset:1024
    ds_write_b128 v13, a[232:235] offset:2048
    ds_write_b128 v13, a[236:239] offset:3072
L_poll_8:
    s_waitcnt vmcnt(1)
    v_cmp_ne_u32 vcc, s32, v249
    s_nop 0
    s_cbranch_vccz L_polldone_9
    buffer_load_dword v249, v110, s[16:19], s67 offen sc1
    s_waitcnt vmcnt(1)
    v_cmp_ne_u32 vcc, s32, v250
    s_nop 0
    s_cbranch_vccz L_polldone_9
    buffer_load_dword v250, v110, s[16:19], s67 offen sc1
    s_add_u32 s39, s39, 1
    s_cmp_lt_u32 s39, 1048576
    s_cbranch_scc1 L_poll_8
    s_branch L_end
L_polldone_9:
    buffer_load_dwordx4 a[64:67], v1, s[16:19], s68 offen offset:0 sc1
    buffer_load_dwordx4 a[68:71], v1, s[16:19], s68 offen offset:1024 sc1
    buffer_load_dwordx4 a[72:75], v1, s[16:19], s68 offen offset:2048 sc1
    s_lshr_b32 s62, s30, 1
    s_xor_b32 s62, s62, s29
    s_and_b32 s62, s62, 1
    s_lshl_b32 s62, s62, 3
    v_xor_b32 v7, s62, v7
    s_add_u32 s40, s40, 0x10000
    s_add_u32 s42, s42, 0x10000
    s_add_u32 s41, s41, 0x2000
    s_add_u32 s43, s43, 0x2000
    v_mov_b32 v80, 0x3f803f80
    v_mov_b32 v81, 0x3f803f80
    v_mov_b32 v82, 0x3f803f80
    v_mov_b32 v83, 0x3f803f80
    s_add_u32 s38, s38, 0x100
    s_add_u32 s25, s25, 0x100
    s_mov_b32 s12, s52
    s_mov_b32 s13, s53
    s_add_u32 s24, s24, 0x80
    s_add_u32 s67, s24, 73728
    s_bfe_u32 s62, s57, 0x60009
    s_add_u32 s62, s62, s69
    s_add_u32 s62, s62, 73856
    v_xor_b32 v8, 0x200, v8
    v_xor_b32 v9, 0x200, v9
    v_xor_b32 v248, 0x2000, v100
    s_mov_b32 s37, 0x3fb8aa3b
    s_mov_b32 s56, 0x3fb8aa3b
    buffer_load_dwordx4 a[76:79], v1, s[16:19], s68 offen offset:3072 sc1
    s_add_u32 s66, s68, 4096
    ds_write_b128 v13, a[240:243] offset:4096
    buffer_load_dwordx4 a[80:83], v1, s[16:19], s66 offen offset:0 sc1
    ds_write_b128 v13, a[244:247] offset:5120
    buffer_load_dwordx4 a[84:87], v1, s[16:19], s66 offen offset:1024 sc1
    ds_write_b128 v13, a[248:251] offset:6144
    buffer_load_dwordx4 a[88:91], v1, s[16:19], s66 offen offset:2048 sc1
    ds_write_b128 v13, a[252:255] offset:7168
    s_waitcnt vmcnt(6)
    v_mfma_f32_32x32x16_bf16 v[224:239], a[0:3], a[64:67], 0
    buffer_load_dwordx4 a[92:95], v1, s[16:19], s66 offen offset:3072 sc1
    s_add_u32 s66, s66, 4096
    ds_read_b64_tr_b16 v[184:185], v221 offset:0
    ds_read_b64_tr_b16 v[186:187], v221 offset:512
    s_waitcnt lgkmcnt(14)
    v_mfma_f32_16x16x32_bf16 v[112:115], v[216:219], v[208:211], v[112:115]
    ds_write_b128 v12, v[208:211] offset:38912
    v_mfma_f32_32x32x16_bf16 v[16:31], a[4:7], a[64:67], v[16:31]
    ds_read_b64_tr_b16 v[188:189], v221 offset:1024
    ds_read_b64_tr_b16 v[190:191], v221 offset:1536
    s_waitcnt lgkmcnt(14)
    v_mfma_f32_16x16x32_bf16 v[112:115], v[216:219], v[212:215], v[112:115]
    ds_write_b128 v12, v[212:215] offset:39936
    s_waitcnt vmcnt(6)
    v_mfma_f32_32x32x16_bf16 v[224:239], a[8:11], a[68:71], v[224:239]
    buffer_load_dwordx4 a[96:99], v1, s[16:19], s66 offen offset:0 sc1
    ds_read_b64_tr_b16 v[192:193], v221 offset:2048
    ds_read_b64_tr_b16 v[194:195], v221 offset:2560
    s_waitcnt lgkmcnt(6)
    v_mfma_f32_16x16x32_bf16 v[128:131], v[216:219], v[184:187], 0
    ds_write_b128 v13, v[184:187] offset:0
    v_mfma_f32_32x32x16_bf16 v[16:31], a[12:15], a[68:71], v[16:31]
    ds_read_b64_tr_b16 v[196:197], v221 offset:3072
    ds_read_b64_tr_b16 v[198:199], v221 offset:3584
    s_waitcnt lgkmcnt(6)
    v_mfma_f32_16x16x32_bf16 v[128:131], v[216:219], v[188:191], v[128:131]
    ds_write_b128 v13, v[188:191] offset:1024
    s_waitcnt vmcnt(6)
    v_mfma_f32_32x32x16_bf16 v[224:239], a[16:19], a[72:75], v[224:239]
    buffer_load_dwordx4 a[100:103], v1, s[16:19], s66 offen offset:1024 sc1
    ds_read_b64_tr_b16 v[200:201], v221 offset:4096
    ds_read_b64_tr_b16 v[202:203], v221 offset:4608
    s_waitcnt lgkmcnt(6)
    v_mfma_f32_16x16x32_bf16 v[128:131], v[216:219], v[192:195], v[128:131]
    ds_write_b128 v13, v[192:195] offset:2048
    v_mfma_f32_32x32x16_bf16 v[16:31], a[20:23], a[72:75], v[16:31]
    ds_read_b64_tr_b16 v[204:205], v221 offset:5120
    ds_read_b64_tr_b16 v[206:207], v221 offset:5632
    s_waitcnt lgkmcnt(6)
    v_mfma_f32_16x16x32_bf16 v[128:131], v[216:219], v[196:199], v[128:131]
    ds_write_b128 v13, v[196:199] offset:3072
    s_waitcnt vmcnt(6)
    v_mfma_f32_32x32x16_bf16 v[224:239], a[24:27], a[76:79], v[224:239]
    buffer_load_dwordx4 a[104:107], v1, s[16:19], s66 offen offset:2048 sc1
    ds_read_b64_tr_b16 v[208:209], v221 offset:6144
    ds_read_b64_tr_b16 v[210:211], v221 offset:6656
    s_waitcnt lgkmcnt(6)
    v_mfma_f32_16x16x32_bf16 v[128:131], v[216:219], v[200:203], v[128:131]
    ds_write_b128 v13, v[200:203] offset:4096
    v_mfma_f32_32x32x16_bf16 v[16:31], a[28:31], a[76:79], v[16:31]
    ds_read_b64_tr_b16 v[212:213], v221 offset:7168
    ds_read_b64_tr_b16 v[214:215], v221 offset:7680
    s_waitcnt lgkmcnt(6)
    v_mfma_f32_16x16x32_bf16 v[128:131], v[216:219], v[204:207], v[128:131]
    ds_write_b128 v13, v[204:207] offset:5120
    s_waitcnt vmcnt(6)
    v_mfma_f32_32x32x16_bf16 v[224:239], a[32:35], a[80:83], v[224:239]
    buffer_load_dwordx4 a[108:111], v1, s[16:19], s66 offen offset:3072 sc1
    s_add_u32 s66, s66, 4096
    ds_read_b64_tr_b16 v[184:185], v220 offset:0
    ds_read_b64_tr_b16 v[186:187], v220 offset:512
    s_waitcnt lgkmcnt(6)
    v_mfma_f32_16x16x32_bf16 v[128:131], v[216:219], v[208:211], v[128:131]
    ds_write_b128 v13, v[208:211] offset:6144
    v_mfma_f32_32x32x16_bf16 v[16:31], a[36:39], a[80:83], v[16:31]
    ds_read_b64_tr_b16 v[188:189], v220 offset:1024
    ds_read_b64_tr_b16 v[190:191], v220 offset:1536
    s_waitcnt lgkmcnt(6)
    v_mfma_f32_16x16x32_bf16 v[128:131], v[216:219], v[212:215], v[128:131]
    ds_write_b128 v13, v[212:215] offset:7168
    s_waitcnt vmcnt(6)
    v_mfma_f32_32x32x16_bf16 v[224:239], a[40:43], a[84:87], v[224:239]
    buffer_load_dwordx4 a[112:115], v1, s[16:19], s66 offen offset:0 sc1
    ds_read_b64_tr_b16 v[192:193], v220 offset:2048
    ds_read_b64_tr_b16 v[194:195], v220 offset:2560
    s_waitcnt lgkmcnt(6)
    v_mfma_f32_16x16x32_bf16 v[144:147], v[216:219], v[184:187], 0
    v_mfma_f32_32x32x16_bf16 v[16:31], a[44:47], a[84:87], v[16:31]
    ds_read_b64_tr_b16 v[196:197], v220 offset:3072
    ds_read_b64_tr_b16 v[198:199], v220 offset:3584
    s_waitcnt lgkmcnt(5)
    v_mfma_f32_16x16x32_bf16 v[144:147], v[216:219], v[188:191], v[144:147]
    s_waitcnt vmcnt(6)
    v_mfma_f32_32x32x16_bf16 v[224:239], a[48:51], a[88:91], v[224:239]
    ds_read_b64_tr_b16 v[176:177], v109 offset:0
    ds_read_b64_tr_b16 v[178:179], v109 offset:1024
    buffer_load_dwordx4 a[116:119], v1, s[16:19], s66 offen offset:1024 sc1
    ds_read_b64_tr_b16 v[200:201], v220 offset:4096
    ds_read_b64_tr_b16 v[202:203], v220 offset:4608
    s_waitcnt lgkmcnt(6)
    v_mfma_f32_16x16x32_bf16 v[144:147], v[216:219], v[192:195], v[144:147]
    v_mfma_f32_32x32x16_bf16 v[16:31], a[52:55], a[88:91], v[16:31]
    ds_read_b64_tr_b16 v[180:181], v98 offset:0
    ds_read_b64_tr_b16 v[182:183], v98 offset:1024
    ds_read_b64_tr_b16 v[204:205], v220 offset:5120
    ds_read_b64_tr_b16 v[206:207], v220 offset:5632
    s_waitcnt lgkmcnt(8)
    v_mfma_f32_16x16x32_bf16 v[144:147], v[216:219], v[196:199], v[144:147]
    s_waitcnt vmcnt(6)
    v_mfma_f32_32x32x16_bf16 v[224:239], a[56:59], a[92:95], v[224:239]
    ds_read_b64_tr_b16 v[160:161], v109 offset:2048
    ds_read_b64_tr_b16 v[162:163], v109 offset:3072
    buffer_load_dwordx4 a[120:123], v1, s[16:19], s66 offen offset:2048 sc1
    ds_read_b64_tr_b16 v[208:209], v220 offset:6144
    ds_read_b64_tr_b16 v[210:211], v220 offset:6656
    s_waitcnt lgkmcnt(8)
    v_mfma_f32_16x16x32_bf16 v[144:147], v[216:219], v[200:203], v[144:147]
    v_mfma_f32_32x32x16_bf16 v[16:31], a[60:63], a[92:95], v[16:31]
    ds_read_b64_tr_b16 v[164:165], v98 offset:2048
    ds_read_b64_tr_b16 v[166:167], v98 offset:3072
    ds_read_b64_tr_b16 v[212:213], v220 offset:7168
    ds_read_b64_tr_b16 v[214:215], v220 offset:7680
    s_waitcnt lgkmcnt(8)
    v_mfma_f32_16x16x32_bf16 v[144:147], v[216:219], v[204:207], v[144:147]
    s_waitcnt vmcnt(6)
    v_mfma_f32_32x32x16_bf16 v[224:239], v[176:179], a[96:99], v[224:239]
    ds_read_b64_tr_b16 v[168:169], v109 offset:4096
    ds_read_b64_tr_b16 v[170:171], v109 offset:5120
    buffer_load_dwordx4 a[124:127], v1, s[16:19], s66 offen offset:3072 sc1
    s_add_u32 s66, s66, 4096
    s_waitcnt lgkmcnt(6)
    v_mfma_f32_16x16x32_bf16 v[144:147], v[216:219], v[208:211], v[144:147]
    v_mfma_f32_32x32x16_bf16 v[16:31], v[180:183], a[96:99], v[16:31]
    ds_read_b64_tr_b16 v[172:173], v98 offset:4096
    ds_read_b64_tr_b16 v[174:175], v98 offset:5120
    s_waitcnt lgkmcnt(4)
    v_mfma_f32_16x16x32_bf16 v[144:147], v[216:219], v[212:215], v[144:147]
    s_waitcnt vmcnt(6)
    v_mfma_f32_32x32x16_bf16 v[224:239], v[160:163], a[100:103], v[224:239]
    ds_read_b64_tr_b16 v[176:177], v109 offset:6144
    ds_read_b64_tr_b16 v[178:179], v109 offset:7168
    s_mul_i32 s63, s30, 0x180
    s_add_u32 s63, s63, 129024
    v_add_u32 v220, s63, v3
    v_cndmask_b32_e64 v112, v113, v112, s[58:59]
    v_cndmask_b32_e64 v128, v129, v128, s[58:59]
    v_cndmask_b32_e64 v144, v145, v144, s[58:59]
    ds_write_b32 v220, v144 offset:0
    ds_write_b32 v220, v112 offset:128
    ds_write_b32 v220, v128 offset:256
    v_mfma_f32_32x32x16_bf16 v[16:31], v[164:167], a[100:103], v[16:31]
    ds_read_b64_tr_b16 v[180:181], v98 offset:6144
    ds_read_b64_tr_b16 v[182:183], v98 offset:7168
    s_waitcnt vmcnt(5) lgkmcnt(9)
    v_mfma_f32_32x32x16_bf16 v[224:239], v[168:171], a[104:107], v[224:239]
    ds_read_b64_tr_b16 v[160:161], v109 offset:8192
    ds_read_b64_tr_b16 v[162:163], v109 offset:9216
    s_waitcnt lgkmcnt(9)
    v_mfma_f32_32x32x16_bf16 v[16:31], v[172:175], a[104:107], v[16:31]
    ds_read_b64_tr_b16 v[164:165], v109 offset:10240
    ds_read_b64_tr_b16 v[166:167], v109 offset:11264
    s_waitcnt vmcnt(4) lgkmcnt(9)
    v_mfma_f32_32x32x16_bf16 v[224:239], v[176:179], a[108:111], v[224:239]
    ds_read_b64_tr_b16 v[168:169], v109 offset:12288
    ds_read_b64_tr_b16 v[170:171], v109 offset:13312
    s_waitcnt lgkmcnt(6)
    v_mfma_f32_32x32x16_bf16 v[16:31], v[180:183], a[108:111], v[16:31]
    ds_read_b64_tr_b16 v[172:173], v109 offset:14336
    ds_read_b64_tr_b16 v[174:175], v109 offset:15360
    s_waitcnt vmcnt(3) lgkmcnt(6)
    v_mfma_f32_32x32x16_bf16 v[224:239], v[160:163], a[112:115], v[224:239]
    ds_read_b64_tr_b16 v[176:177], v98 offset:8192
    ds_read_b64_tr_b16 v[178:179], v98 offset:9216
    s_waitcnt vmcnt(2) lgkmcnt(6)
    v_mfma_f32_32x32x16_bf16 v[224:239], v[164:167], a[116:119], v[224:239]
    ds_read_b64_tr_b16 v[180:181], v98 offset:10240
    ds_read_b64_tr_b16 v[182:183], v98 offset:11264
    s_waitcnt vmcnt(1) lgkmcnt(6)
    v_mfma_f32_32x32x16_bf16 v[224:239], v[168:171], a[120:123], v[224:239]
    ds_read_b64_tr_b16 v[160:161], v98 offset:12288
    ds_read_b64_tr_b16 v[162:163], v98 offset:13312
    s_waitcnt vmcnt(0) lgkmcnt(6)
    v_mfma_f32_32x32x16_bf16 v[224:239], v[172:175], a[124:127], v[224:239]
    ds_read_b64_tr_b16 v[164:165], v98 offset:14336
    ds_read_b64_tr_b16 v[166:167], v98 offset:15360
    s_waitcnt lgkmcnt(6)
    v_mfma_f32_32x32x16_bf16 v[16:31], v[176:179], a[112:115], v[16:31]
    s_waitcnt lgkmcnt(4)
    v_mfma_f32_32x32x16_bf16 v[16:31], v[180:183], a[116:119], v[16:31]
    s_nop 5
    ds_write_b128 v248, v[224:227] offset:0
    ds_write_b128 v248, v[228:231] offset:1024
    s_waitcnt lgkmcnt(4)
    v_mfma_f32_32x32x16_bf16 v[16:31], v[160:163], a[120:123], v[16:31]
    ds_write_b128 v248, v[232:235] offset:2048
    s_waitcnt lgkmcnt(3)
    v_mfma_f32_32x32x16_bf16 v[16:31], v[164:167], a[124:127], v[16:31]
    ds_write_b128 v248, v[236:239] offset:3072
    s_waitcnt lgkmcnt(0)
    s_barrier
    ds_read_b128 v[224:227], v100 offset:0
    ds_read_b128 v[228:231], v100 offset:1024
    ds_read_b128 v[232:235], v100 offset:2048
    ds_read_b128 v[236:239], v100 offset:3072
    s_waitcnt lgkmcnt(3)
    s_nop 3
    v_pk_add_f32 v[16:17], v[16:17], v[224:225]
    v_pk_add_f32 v[18:19], v[18:19], v[226:227]
    v_cvt_pk_bf16_f32 v240, v16, v17
    v_cvt_pk_bf16_f32 v241, v18, v19
    s_waitcnt lgkmcnt(2)
    v_pk_add_f32 v[20:21], v[20:21], v[228:229]
    v_pk_add_f32 v[22:23], v[22:23], v[230:231]
    v_cvt_pk_bf16_f32 v242, v20, v21
    v_cvt_pk_bf16_f32 v243, v22, v23
    s_waitcnt lgkmcnt(1)
    v_pk_add_f32 v[24:25], v[24:25], v[232:233]
    v_pk_add_f32 v[26:27], v[26:27], v[234:235]
    v_cvt_pk_bf16_f32 v244, v24, v25
    v_cvt_pk_bf16_f32 v245, v26, v27
    s_waitcnt lgkmcnt(0)
    v_pk_add_f32 v[28:29], v[28:29], v[236:237]
    v_pk_add_f32 v[30:31], v[30:31], v[238:239]
    v_cvt_pk_bf16_f32 v246, v28, v29
    v_cvt_pk_bf16_f32 v247, v30, v31
    s_cmp_eq_u32 s34, 0
    s_cbranch_scc1 L_xpubsA0_slow
    buffer_store_dwordx4 v[240:243], v1, s[16:19], s57 offen
    buffer_store_dwordx4 v[244:247], v1, s[16:19], s57 offen offset:1024
    v_pk_add_f32 v[116:117], v[16:17], v[18:19]
    v_pk_mul_f32 v[118:119], v[16:17], v[16:17]
    v_pk_fma_f32 v[118:119], v[18:19], v[18:19], v[118:119]
    v_pk_add_f32 v[116:117], v[116:117], v[20:21]
    v_pk_fma_f32 v[118:119], v[20:21], v[20:21], v[118:119]
    v_pk_add_f32 v[116:117], v[116:117], v[22:23]
    v_pk_fma_f32 v[118:119], v[22:23], v[22:23], v[118:119]
    v_pk_add_f32 v[116:117], v[116:117], v[24:25]
    v_pk_fma_f32 v[118:119], v[24:25], v[24:25], v[118:119]
    v_pk_add_f32 v[116:117], v[116:117], v[26:27]
    v_pk_fma_f32 v[118:119], v[26:27], v[26:27], v[118:119]
    v_pk_add_f32 v[116:117], v[116:117], v[28:29]
    v_pk_fma_f32 v[118:119], v[28:29], v[28:29], v[118:119]
    v_pk_add_f32 v[116:117], v[116:117], v[30:31]
    v_pk_fma_f32 v[118:119], v[30:31], v[30:31], v[118:119]
    v_add_f32 v116, v116, v117
    v_add_f32 v118, v118, v119
    s_nop 1
    v_permlane32_swap_b32 v116, v118
    v_add_f32 v116, v116, v118
    v_and_or_b32 v116, v116, -16, 2
    buffer_store_dword v116, v7, s[16:19], s61 offen
    ds_write_b128 v12, v[184:187] offset:0
    ds_write_b128 v12, v[188:191] offset:1024
    ds_write_b128 v12, v[192:195] offset:2048
    s_mov_b64 exec, 1
    s_waitcnt vmcnt(1)
    buffer_store_dword v96, v111, s[16:19], s62 offen
    s_mov_b64 exec, -1
L_xpubsA0_join:
    ds_write_b128 v12, v[196:199] offset:3072
    ds_write_b128 v12, v[200:203] offset:4096
    ds_write_b128 v12, v[204:207] offset:5120
    ds_write_b128 v12, v[208:211] offset:6144
    ds_write_b128 v12, v[212:215] offset:7168
    s_add_u32 s33, s33, 1
    buffer_load_dword v254, v110, s[16:19], s67 offen sc1
    s_mov_b32 s39, 0
    buffer_load_dword v255, v110, s[16:19], s67 offen sc1
    v_add_u32 v220, 129024, v3
    ds_read_b32 v184, v220 offset:0
    ds_read_b32 v185, v220 offset:384
    ds_read_b32 v186, v220 offset:768
    ds_read_b32 v187, v220 offset:1152
    ds_read_b32 v188, v220 offset:128
    ds_read_b32 v189, v220 offset:512
    ds_read_b32 v190, v220 offset:896
    ds_read_b32 v191, v220 offset:1280
    ds_read_b32 v192, v220 offset:256
    ds_read_b32 v193, v220 offset:640
    ds_read_b32 v194, v220 offset:1024
    ds_read_b32 v195, v220 offset:1408
    s_waitcnt lgkmcnt(10)
    v_add_f32 v184, v184, v185
    s_waitcnt lgkmcnt(8)
    v_add_f32 v186, v186, v187
    v_add_f32 v184, v184, v186
    s_waitcnt lgkmcnt(6)
    v_add_f32 v188, v188, v189
    s_waitcnt lgkmcnt(4)
    v_add_f32 v190, v190, v191
    v_add_f32 v188, v188, v190
    s_waitcnt lgkmcnt(2)
    v_add_f32 v192, v192, v193
    s_waitcnt lgkmcnt(0)
    v_add_f32 v194, v194, v195
    v_add_f32 v192, v192, v194
    ds_write_b32 v9, v184 offset:0
    ds_write_b32 v9, v188 offset:128
    ds_write_b32 v9, v192 offset:256
    ds_read_b128 v[164:167], v2 offset:0
    ds_read_b128 v[160:163], v1 offset:32768
    ds_read_b128 v[172:175], v2 offset:1024
    ds_read_b128 v[168:171], v1 offset:33792
    ds_read_b128 v[200:203], v8 offset:128
    ds_read_b128 v[204:207], v8 offset:160
    ds_read_b128 v[208:211], v8 offset:192
    ds_read_b128 v[212:215], v8 offset:224
    ds_read_b32 v248, v9 offset:256
    s_waitcnt lgkmcnt(0)
L_poll_10:
    s_waitcnt vmcnt(1)
    v_cmp_ne_u32 vcc, s32, v254
    s_nop 0
    s_cbranch_vccz L_polldone_11
    buffer_load_dword v254, v110, s[16:19], s67 offen sc1
    s_waitcnt vmcnt(1)
    v_cmp_ne_u32 vcc, s32, v255
    s_nop 0
    s_cbranch_vccz L_polldone_11
    buffer_load_dword v255, v110, s[16:19], s67 offen sc1
    s_add_u32 s39, s39, 1
    s_cmp_lt_u32 s39, 1048576
    s_cbranch_scc1 L_poll_10
    s_branch L_end
L_polldone_11:
    s_nop 1
    s_branch L_loadx
L_layerB:
    s_nop 6
    v_pk_fma_f32 v[200:201], v[112:113], v[250:251], v[200:201] op_sel:[0,0,0] op_sel_hi:[1,0,1]
    v_pk_fma_f32 v[202:203], v[114:115], v[250:251], v[202:203] op_sel:[0,0,0] op_sel_hi:[1,0,1]
    v_pk_fma_f32 v[204:205], v[116:117], v[250:251], v[204:205] op_sel:[0,0,0] op_sel_hi:[1,0,1]
    v_pk_fma_f32 v[206:207], v[118:119], v[250:251], v[206:207] op_sel:[0,0,0] op_sel_hi:[1,0,1]
    v_cvt_pk_bf16_f32 v168, v200, v201
    v_cvt_pk_bf16_f32 v169, v202, v203
    v_cvt_pk_bf16_f32 v170, v204, v205
    v_cvt_pk_bf16_f32 v171, v206, v207
    v_pk_fma_f32 v[208:209], v[120:121], v[250:251], v[208:209] op_sel:[0,0,0] op_sel_hi:[1,0,1]
    v_pk_fma_f32 v[210:211], v[122:123], v[250:251], v[210:211] op_sel:[0,0,0] op_sel_hi:[1,0,1]
    v_pk_fma_f32 v[212:213], v[124:125], v[250:251], v[212:213] op_sel:[0,0,0] op_sel_hi:[1,0,1]
    v_pk_fma_f32 v[214:215], v[126:127], v[250:251], v[214:215] op_sel:[0,0,0] op_sel_hi:[1,0,1]
    v_mfma_f32_32x32x16_bf16 v[144:159], v[64:67], v[168:171], 0
    v_cvt_pk_bf16_f32 v172, v208, v209
    v_cvt_pk_bf16_f32 v173, v210, v211
    v_cvt_pk_bf16_f32 v174, v212, v213
    v_cvt_pk_bf16_f32 v175, v214, v215
    s_nop 1
    v_mfma_f32_32x32x16_bf16 v[112:127], v[68:71], v[172:175], 0
    v_lshlrev_b32 v249, 11, v110
    buffer_load_dword v248, v249, s[16:19], s54 offen sc1
    s_cmp_lt_u32 s33, 2
    s_cbranch_scc1 L_stub7
L_stubret7:
    v_fmac_f32 v232, v128, v216
    v_fmac_f32 v233, v129, v217
    v_fmac_f32 v234, v130, v218
    v_fmac_f32 v235, v131, v219
    v_fmac_f32 v236, v132, v220
    v_fmac_f32 v237, v133, v221
    v_fmac_f32 v238, v134, v222
    v_fmac_f32 v239, v135, v223
    v_cvt_pk_bf16_f32 v232, v232, v233
    v_cvt_pk_bf16_f32 v233, v234, v235
    v_cvt_pk_bf16_f32 v234, v236, v237
    v_cvt_pk_bf16_f32 v235, v238, v239
    ds_write_b128 v101, v[232:235]
    v_pk_fma_f32 v[240:241], v[136:137], v[224:225], v[240:241]
    v_pk_fma_f32 v[242:243], v[138:139], v[226:227], v[242:243]
    v_pk_fma_f32 v[244:245], v[140:141], v[228:229], v[244:245]
    v_pk_fma_f32 v[246:247], v[142:143], v[230:231], v[246:247]
    v_cvt_pk_bf16_f32 v236, v240, v241
    v_cvt_pk_bf16_f32 v237, v242, v243
    v_cvt_pk_bf16_f32 v238, v244, v245
    v_cvt_pk_bf16_f32 v239, v246, v247
    ds_write_b128 v101, v[236:239] offset:1024
L_phikret:
    v_exp_f32 v144, v144
    v_exp_f32 v112, v112
    v_exp_f32 v145, v145
    v_exp_f32 v113, v113
    v_exp_f32 v146, v146
    v_exp_f32 v114, v114
    v_exp_f32 v147, v147
    v_exp_f32 v115, v115
    v_exp_f32 v148, v148
    v_exp_f32 v116, v116
    v_exp_f32 v149, v149
    v_exp_f32 v117, v117
    v_exp_f32 v150, v150
    v_exp_f32 v118, v118
    v_exp_f32 v151, v151
    v_exp_f32 v119, v119
    v_exp_f32 v152, v152
    v_exp_f32 v120, v120
    v_exp_f32 v153, v153
    v_exp_f32 v121, v121
    v_exp_f32 v154, v154
    v_exp_f32 v122, v122
    v_exp_f32 v155, v155
    v_exp_f32 v123, v123
    v_exp_f32 v156, v156
    v_exp_f32 v124, v124
    v_exp_f32 v157, v157
    v_exp_f32 v125, v125
    v_exp_f32 v158, v158
    v_exp_f32 v126, v126
    v_exp_f32 v159, v159
    v_exp_f32 v127, v127
    v_pk_add_f32 v[128:129], v[144:145], v[146:147]
    v_pk_add_f32 v[132:133], v[112:113], v[114:115]
    v_pk_add_f32 v[128:129], v[128:129], v[148:149]
    v_pk_add_f32 v[132:133], v[132:133], v[116:117]
    v_pk_add_f32 v[128:129], v[128:129], v[150:151]
    v_pk_add_f32 v[132:133], v[132:133], v[118:119]
    v_pk_add_f32 v[130:131], v[152:153], v[154:155]
    v_pk_add_f32 v[134:135], v[120:121], v[122:123]
    v_pk_add_f32 v[130:131], v[130:131], v[156:157]
    v_pk_add_f32 v[134:135], v[134:135], v[124:125]
    v_pk_add_f32 v[130:131], v[130:131], v[158:159]
    v_pk_add_f32 v[134:135], v[134:135], v[126:127]
    v_add_f32 v128, v128, v129
    v_add_f32 v132, v132, v133
    v_add_f32 v129, v130, v131
    v_add_f32 v133, v134, v135
    s_nop 0
    v_permlane32_swap_b32 v128, v129
    v_permlane32_swap_b32 v132, v133
    v_add_f32 v128, v128, v129
    v_add_f32 v132, v132, v133
    v_mov_b32 v129, v128
    v_mov_b32 v133, v132
    s_nop 0
    v_permlane32_swap_b32 v128, v129
    v_permlane32_swap_b32 v132, v133
    v_max3_f32 v130, v128, v129, v132
    v_rcp_f32 v128, v128
    v_max_f32 v130, v130, v133
    v_rcp_f32 v129, v129
    v_cmp_lt_f32 vcc, 0x67800000, v130
    v_rcp_f32 v132, v132
    v_rcp_f32 v133, v133
    s_cbranch_vccnz L_phikmax
    v_pk_mul_f32 v[144:145], v[144:145], v[128:129] op_sel:[0,0] op_sel_hi:[1,0]
    v_pk_mul_f32 v[146:147], v[146:147], v[128:129] op_sel:[0,0] op_sel_hi:[1,0]
    v_pk_mul_f32 v[148:149], v[148:149], v[128:129] op_sel:[0,0] op_sel_hi:[1,0]
    v_pk_mul_f32 v[150:151], v[150:151], v[128:129] op_sel:[0,0] op_sel_hi:[1,0]
    v_cvt_pk_bf16_f32 v200, v144, v145
    v_cvt_pk_bf16_f32 v201, v146, v147
    v_cvt_pk_bf16_f32 v202, v148, v149
    v_cvt_pk_bf16_f32 v203, v150, v151
    ds_write_b128 v100, v[200:203] offset:0
    v_pk_mul_f32 v[152:153], v[152:153], v[128:129] op_sel:[0,1] op_sel_hi:[1,1]
    v_pk_mul_f32 v[154:155], v[154:155], v[128:129] op_sel:[0,1] op_sel_hi:[1,1]
    v_pk_mul_f32 v[156:157], v[156:157], v[128:129] op_sel:[0,1] op_sel_hi:[1,1]
    v_pk_mul_f32 v[158:159], v[158:159], v[128:129] op_sel:[0,1] op_sel_hi:[1,1]
    v_cvt_pk_bf16_f32 v204, v152, v153
    v_cvt_pk_bf16_f32 v205, v154, v155
    v_cvt_pk_bf16_f32 v206, v156, v157
    v_cvt_pk_bf16_f32 v207, v158, v159
    ds_write_b128 v100, v[204:207] offset:1024
    v_pk_mul_f32 v[112:113], v[112:113], v[132:133] op_sel:[0,0] op_sel_hi:[1,0]
    v_pk_mul_f32 v[114:115], v[114:115], v[132:133] op_sel:[0,0] op_sel_hi:[1,0]
    v_pk_mul_f32 v[116:117], v[116:117], v[132:133] op_sel:[0,0] op_sel_hi:[1,0]
    v_pk_mul_f32 v[118:119], v[118:119], v[132:133] op_sel:[0,0] op_sel_hi:[1,0]
    v_cvt_pk_bf16_f32 v208, v112, v113
    v_cvt_pk_bf16_f32 v209, v114, v115
    v_cvt_pk_bf16_f32 v210, v116, v117
    v_cvt_pk_bf16_f32 v211, v118, v119
    ds_write_b128 v100, v[208:211] offset:2048
    v_pk_mul_f32 v[120:121], v[120:121], v[132:133] op_sel:[0,1] op_sel_hi:[1,1]
    v_pk_mul_f32 v[122:123], v[122:123], v[132:133] op_sel:[0,1] op_sel_hi:[1,1]
    v_pk_mul_f32 v[124:125], v[124:125], v[132:133] op_sel:[0,1] op_sel_hi:[1,1]
    v_pk_mul_f32 v[126:127], v[126:127], v[132:133] op_sel:[0,1] op_sel_hi:[1,1]
    v_cvt_pk_bf16_f32 v212, v120, v121
    v_cvt_pk_bf16_f32 v213, v122, v123
    v_cvt_pk_bf16_f32 v214, v124, v125
    v_cvt_pk_bf16_f32 v215, v126, v127
    ds_write_b128 v100, v[212:215] offset:3072
    s_cmp_lt_u32 s33, 2
    s_cbranch_scc1 L_stub8
    s_waitcnt vmcnt(1)
L_stubret8:
    s_waitcnt lgkmcnt(0)
    s_barrier
    ds_read_b64_tr_b16 v[112:113], v76 offset:0
    ds_read_b64_tr_b16 v[114:115], v76 offset:128
    ds_read_b128 v[128:131], v77 offset:0
    ds_read_b64_tr_b16 v[116:117], v76 offset:4096
    ds_read_b64_tr_b16 v[118:119], v76 offset:4224
    ds_read_b128 v[132:135], v77 offset:2048
    ds_read_b64_tr_b16 v[120:121], v76 offset:8192
    ds_read_b64_tr_b16 v[122:123], v76 offset:8320
    ds_read_b128 v[136:139], v77 offset:4096
    ds_read_b64_tr_b16 v[124:125], v76 offset:12288
    ds_read_b64_tr_b16 v[126:127], v76 offset:12416
    ds_read_b128 v[140:143], v77 offset:6144
    s_mov_b32 s62, 0x00010001
    s_mov_b32 s63, 0x00010001
    s_waitcnt lgkmcnt(9)
    v_mfma_f32_16x16x32_bf16 v[216:219], v[112:115], v[128:131], 0
    v_mfma_f32_16x16x32_bf16 v[220:223], v[112:115], v[80:83], 0
    s_waitcnt lgkmcnt(6)
    v_mfma_f32_16x16x32_bf16 v[216:219], v[116:119], v[132:135], v[216:219]
    v_mfma_f32_16x16x32_bf16 v[220:223], v[116:119], v[80:83], v[220:223]
    s_waitcnt lgkmcnt(3)
    v_mfma_f32_16x16x32_bf16 v[216:219], v[120:123], v[136:139], v[216:219]
    v_mfma_f32_16x16x32_bf16 v[220:223], v[120:123], v[80:83], v[220:223]
    s_waitcnt lgkmcnt(0)
    v_mfma_f32_16x16x32_bf16 v[216:219], v[124:127], v[140:143], v[216:219]
    v_mfma_f32_16x16x32_bf16 v[220:223], v[124:127], v[80:83], v[220:223]
    s_nop 6
    v_cvt_pk_bf16_f32 v216, v216, v217
    v_cvt_pk_bf16_f32 v217, v218, v219
    buffer_store_dwordx2 v[216:217], v97, s[16:19], s48 offen sc1
    s_mov_b64 exec, s[62:63]
    buffer_store_dwordx4 v[220:223], v0, s[16:19], s49 offen sc1
    s_mov_b64 exec, -1
    v_mfma_f32_32x32x16_bf16 v[144:159], v[176:179], a[0:3], 0
    ds_read_b128 v[168:171], v1 offset:4096
    v_lshrrev_b32 v255, 4, v0
    v_lshl_add_u32 v249, v255, 7, v110
    v_mfma_f32_32x32x16_bf16 v[144:159], v[180:183], a[4:7], v[144:159]
    ds_read_b128 v[172:175], v1 offset:5120
    ds_read_b64_tr_b16 a[0:1], v109 offset:0
    ds_read_b64_tr_b16 a[2:3], v109 offset:1024
    v_lshrrev_b32 v254, 5, v0
    v_lshlrev_b32 v255, 8, v254
    v_mfma_f32_32x32x16_bf16 v[144:159], v[160:163], a[8:11], v[144:159]
    ds_read_b128 v[176:179], v1 offset:6144
    ds_read_b64_tr_b16 a[4:5], v98 offset:0
    ds_read_b64_tr_b16 a[6:7], v98 offset:1024
    v_lshl_add_u32 v255, v110, 2, v255
    v_lshlrev_b32 v254, 4, v254
    v_mfma_f32_32x32x16_bf16 v[144:159], v[164:167], a[12:15], v[144:159]
    ds_read_b128 v[180:183], v1 offset:7168
    ds_read_b64_tr_b16 a[8:9], v109 offset:2048
    ds_read_b64_tr_b16 a[10:11], v109 offset:3072
    v_add_u32 v254, 512, v254
    v_cndmask_b32_e64 v254, v254, v255, s[58:59]
    s_waitcnt lgkmcnt(8)
    v_mfma_f32_32x32x16_bf16 v[144:159], v[168:171], a[16:19], v[144:159]
    ds_read_b128 v[160:163], v1 offset:8192
    ds_read_b64_tr_b16 a[12:13], v98 offset:2048
    ds_read_b64_tr_b16 a[14:15], v98 offset:3072
    v_add_u32 v254, 128896, v254
    s_add_u32 s64, s36, s55
    v_mfma_f32_32x32x16_bf16 v[144:159], v[172:175], a[20:23], v[144:159]
    ds_read_b128 v[164:167], v1 offset:9216
    ds_read_b64_tr_b16 a[16:17], v109 offset:4096
    ds_read_b64_tr_b16 a[18:19], v109 offset:5120
    s_add_u32 s64, s64, 32768
    s_lshl_b32 s63, s29, 3
    s_waitcnt lgkmcnt(8)
    v_mfma_f32_32x32x16_bf16 v[144:159], v[176:179], a[24:27], v[144:159]
    ds_read_b128 v[168:171], v1 offset:10240
    ds_read_b64_tr_b16 a[20:21], v98 offset:4096
    ds_read_b64_tr_b16 a[22:23], v98 offset:5120
    s_add_u32 s65, s24, s63
    s_add_u32 s65, s65, 74752
    v_mfma_f32_32x32x16_bf16 v[144:159], v[180:183], a[28:31], v[144:159]
    ds_read_b128 v[172:175], v1 offset:11264
    ds_read_b64_tr_b16 a[24:25], v109 offset:6144
    ds_read_b64_tr_b16 a[26:27], v109 offset:7168
    s_add_u32 s67, s50, 4096
    s_waitcnt lgkmcnt(8)
    v_mfma_f32_32x32x16_bf16 v[144:159], v[160:163], a[32:35], v[144:159]
    ds_read_b128 v[176:179], v1 offset:12288
    ds_read_b64_tr_b16 a[28:29], v98 offset:6144
    ds_read_b64_tr_b16 a[30:31], v98 offset:7168
    v_mfma_f32_32x32x16_bf16 v[144:159], v[164:167], a[36:39], v[144:159]
    ds_read_b128 v[180:183], v1 offset:13312
    ds_read_b64_tr_b16 a[32:33], v109 offset:8192
    ds_read_b64_tr_b16 a[34:35], v109 offset:9216
    s_waitcnt lgkmcnt(8)
    v_mfma_f32_32x32x16_bf16 v[144:159], v[168:171], a[40:43], v[144:159]
    ds_read_b128 v[160:163], v1 offset:14336
    ds_read_b64_tr_b16 a[36:37], v98 offset:8192
    ds_read_b64_tr_b16 a[38:39], v98 offset:9216
    v_mfma_f32_32x32x16_bf16 v[144:159], v[172:175], a[44:47], v[144:159]
    ds_read_b128 v[164:167], v1 offset:15360
    ds_read_b64_tr_b16 a[40:41], v109 offset:10240
    ds_read_b64_tr_b16 a[42:43], v109 offset:11264
    s_waitcnt lgkmcnt(8)
    v_mfma_f32_32x32x16_bf16 v[144:159], v[176:179], a[48:51], v[144:159]
    ds_read_b128 v[168:171], v1 offset:16384
    ds_read_b64_tr_b16 a[44:45], v98 offset:10240
    ds_read_b64_tr_b16 a[46:47], v98 offset:11264
    v_mfma_f32_32x32x16_bf16 v[144:159], v[180:183], a[52:55], v[144:159]
    ds_read_b128 v[172:175], v1 offset:17408
    ds_read_b64_tr_b16 a[48:49], v109 offset:12288
    ds_read_b64_tr_b16 a[50:51], v109 offset:13312
    s_waitcnt lgkmcnt(8)
    v_mfma_f32_32x32x16_bf16 v[144:159], v[160:163], a[56:59], v[144:159]
    ds_read_b128 v[176:179], v1 offset:18432
    ds_read_b64_tr_b16 a[52:53], v98 offset:12288
    ds_read_b64_tr_b16 a[54:55], v98 offset:13312
    v_mfma_f32_32x32x16_bf16 v[144:159], v[164:167], a[60:63], v[144:159]
    ds_read_b128 v[180:183], v1 offset:19456
    ds_read_b64_tr_b16 a[56:57], v109 offset:14336
    ds_read_b64_tr_b16 a[58:59], v109 offset:15360
    s_waitcnt lgkmcnt(8)
    v_mfma_f32_32x32x16_bf16 v[144:159], v[168:171], a[64:67], v[144:159]
    ds_read_b128 v[160:163], v1 offset:20480
    ds_read_b64_tr_b16 a[60:61], v98 offset:14336
    ds_read_b64_tr_b16 a[62:63], v98 offset:15360
    v_mfma_f32_32x32x16_bf16 v[144:159], v[172:175], a[68:71], v[144:159]
    ds_read_b128 v[164:167], v1 offset:21504
    s_waitcnt lgkmcnt(6)
    v_mfma_f32_32x32x16_bf16 v[144:159], v[176:179], a[72:75], v[144:159]
    ds_read_b128 v[168:171], v1 offset:22528
    v_mfma_f32_32x32x16_bf16 v[144:159], v[180:183], a[76:79], v[144:159]
    ds_read_b128 v[172:175], v1 offset:23552
    s_waitcnt lgkmcnt(2)
    v_mfma_f32_32x32x16_bf16 v[144:159], v[160:163], a[80:83], v[144:159]
    ds_read_b128 v[176:179], v1 offset:24576
    s_add_u32 s48, s48, 524288
    s_add_u32 s49, s49, 131072
    s_barrier
    v_mfma_f32_32x32x16_bf16 v[144:159], v[164:167], a[84:87], v[144:159]
    ds_read_b128 v[180:183], v1 offset:25600
    s_lshl_b32 s60, s30, 13
    s_add_u32 m0, s60, 131072
    s_mov_b32 s61, 131072
    buffer_load_dwordx4 v5, s[12:15], s61 offen offset:0 lds
    s_waitcnt lgkmcnt(2)
    v_mfma_f32_32x32x16_bf16 v[144:159], v[168:171], a[88:91], v[144:159]
    ds_read_b128 v[160:163], v1 offset:26624
    s_add_u32 s61, s61, 7168
    buffer_load_dwordx4 v5, s[12:15], s61 offen offset:1024 lds
    v_mfma_f32_32x32x16_bf16 v[144:159], v[172:175], a[92:95], v[144:159]
    ds_read_b128 v[164:167], v1 offset:27648
    s_add_u32 s61, s61, 7168
    buffer_load_dwordx4 v5, s[12:15], s61 offen offset:2048 lds
    s_waitcnt lgkmcnt(2)
    v_mfma_f32_32x32x16_bf16 v[144:159], v[176:179], a[96:99], v[144:159]
    ds_read_b128 v[168:171], v1 offset:28672
    v_mfma_f32_32x32x16_bf16 v[144:159], v[180:183], a[100:103], v[144:159]
    ds_read_b128 v[172:175], v1 offset:29696
    s_add_u32 s61, s61, 7168
    buffer_load_dwordx4 v5, s[12:15], s61 offen offset:3072 lds
    s_waitcnt lgkmcnt(2)
    v_mfma_f32_32x32x16_bf16 v[144:159], v[160:163], a[104:107], v[144:159]
    ds_read_b128 v[176:179], v1 offset:30720
    s_add_u32 m0, m0, 4096
    s_add_u32 s61, s61, 11264
    buffer_load_dwordx4 v5, s[12:15], s61 offen offset:0 lds
    v_mfma_f32_32x32x16_bf16 v[144:159], v[164:167], a[108:111], v[144:159]
    ds_read_b128 v[180:183], v1 offset:31744
    s_add_u32 s61, s61, 7168
    buffer_load_dwordx4 v5, s[12:15], s61 offen offset:1024 lds
    s_waitcnt lgkmcnt(2)
    v_mfma_f32_32x32x16_bf16 v[144:159], v[168:171], a[112:115], v[144:159]
    v_mfma_f32_32x32x16_bf16 v[144:159], v[172:175], a[116:119], v[144:159]
    s_add_u32 s61, s61, 7168
    buffer_load_dwordx4 v5, s[12:15], s61 offen offset:2048 lds
    s_waitcnt lgkmcnt(0)
    v_mfma_f32_32x32x16_bf16 v[144:159], v[176:179], a[120:123], v[144:159]
    s_add_u32 s61, s61, 7168
    buffer_load_dwordx4 v5, s[12:15], s61 offen offset:3072 lds
    s_mov_b32 s12, s44
    s_mov_b32 s13, s45
    v_mfma_f32_32x32x16_bf16 v[144:159], v[180:183], a[124:127], v[144:159]
    s_waitcnt vmcnt(10)
    v_cmp_ne_u32 vcc, s32, v248
    s_nop 0
    s_cbranch_vccnz L_sfwait
L_sfok:
    s_nop 7
    v_pk_fma_f32 v[184:185], v[144:145], v[252:253], v[184:185] op_sel:[0,0,0] op_sel_hi:[1,0,1]
    v_pk_fma_f32 v[186:187], v[146:147], v[252:253], v[186:187] op_sel:[0,0,0] op_sel_hi:[1,0,1]
    v_pk_fma_f32 v[188:189], v[148:149], v[252:253], v[188:189] op_sel:[0,0,0] op_sel_hi:[1,0,1]
    v_pk_fma_f32 v[190:191], v[150:151], v[252:253], v[190:191] op_sel:[0,0,0] op_sel_hi:[1,0,1]
    v_cvt_pk_bf16_f32 v160, v184, v185
    v_cvt_pk_bf16_f32 v161, v186, v187
    v_cvt_pk_bf16_f32 v162, v188, v189
    v_cvt_pk_bf16_f32 v163, v190, v191
    v_pk_fma_f32 v[192:193], v[152:153], v[252:253], v[192:193] op_sel:[0,0,0] op_sel_hi:[1,0,1]
    v_pk_fma_f32 v[194:195], v[154:155], v[252:253], v[194:195] op_sel:[0,0,0] op_sel_hi:[1,0,1]
    buffer_load_dword v224, v249, s[16:19], s51 offen offset:0
    v_pk_fma_f32 v[196:197], v[156:157], v[252:253], v[196:197] op_sel:[0,0,0] op_sel_hi:[1,0,1]
    v_pk_fma_f32 v[198:199], v[158:159], v[252:253], v[198:199] op_sel:[0,0,0] op_sel_hi:[1,0,1]
    v_mfma_f32_32x32x16_bf16 v[112:127], v[64:67], v[160:163], 0
    v_cvt_pk_bf16_f32 v164, v192, v193
    v_cvt_pk_bf16_f32 v165, v194, v195
    buffer_load_dword v225, v249, s[16:19], s51 offen offset:512
    v_cvt_pk_bf16_f32 v166, v196, v197
    v_cvt_pk_bf16_f32 v167, v198, v199
    s_nop 1
    v_mfma_f32_32x32x16_bf16 v[128:143], v[68:71], v[164:167], 0
L_phiqret:
    s_nop 3
    v_exp_f32 v112, v112
    buffer_load_dword v226, v249, s[16:19], s51 offen offset:1024
    s_nop 5
    v_exp_f32 v128, v128
    v_exp_f32 v113, v113
    v_exp_f32 v129, v129
    v_exp_f32 v114, v114
    v_exp_f32 v130, v130
    buffer_load_dword v227, v249, s[16:19], s51 offen offset:1536
    v_exp_f32 v115, v115
    v_exp_f32 v131, v131
    v_exp_f32 v116, v116
    v_exp_f32 v132, v132
    v_exp_f32 v117, v117
    buffer_load_dwordx4 v[232:235], v1, s[16:19], s50 offen offset:0
    v_exp_f32 v133, v133
    v_exp_f32 v118, v118
    v_exp_f32 v134, v134
    v_exp_f32 v119, v119
    v_exp_f32 v135, v135
    buffer_load_dwordx4 v[236:239], v1, s[16:19], s50 offen offset:1024
    v_exp_f32 v120, v120
    v_exp_f32 v136, v136
    v_exp_f32 v121, v121
    v_exp_f32 v137, v137
    v_exp_f32 v122, v122
    buffer_load_dwordx4 v[240:243], v1, s[16:19], s50 offen offset:2048
    v_exp_f32 v138, v138
    v_exp_f32 v123, v123
    v_exp_f32 v139, v139
    v_exp_f32 v124, v124
    v_exp_f32 v140, v140
    buffer_load_dwordx4 v[244:247], v1, s[16:19], s50 offen offset:3072
    v_exp_f32 v125, v125
    v_exp_f32 v141, v141
    v_exp_f32 v126, v126
    v_exp_f32 v142, v142
    v_exp_f32 v127, v127
    buffer_load_dwordx4 v[168:171], v1, s[16:19], s67 offen offset:0
    v_exp_f32 v143, v143
    v_pk_add_f32 v[216:217], v[112:113], v[114:115]
    v_pk_add_f32 v[220:221], v[128:129], v[130:131]
    v_pk_add_f32 v[216:217], v[216:217], v[116:117]
    v_pk_add_f32 v[220:221], v[220:221], v[132:133]
    buffer_load_dwordx4 v[172:175], v1, s[16:19], s67 offen offset:1024
    v_pk_add_f32 v[216:217], v[216:217], v[118:119]
    v_pk_add_f32 v[220:221], v[220:221], v[134:135]
    v_pk_add_f32 v[218:219], v[120:121], v[122:123]
    v_pk_add_f32 v[222:223], v[136:137], v[138:139]
    v_pk_add_f32 v[218:219], v[218:219], v[124:125]
    buffer_load_dwordx4 v[176:179], v1, s[16:19], s67 offen offset:2048
    v_pk_add_f32 v[222:223], v[222:223], v[140:141]
    v_pk_add_f32 v[218:219], v[218:219], v[126:127]
    v_pk_add_f32 v[222:223], v[222:223], v[142:143]
    v_add_f32 v216, v216, v217
    v_add_f32 v220, v220, v221
    buffer_load_dwordx4 v[180:183], v1, s[16:19], s67 offen offset:3072
    v_add_f32 v217, v218, v219
    v_add_f32 v221, v222, v223
    s_nop 0
    v_permlane32_swap_b32 v216, v217
    v_permlane32_swap_b32 v220, v221
    v_add_f32 v216, v216, v217
    v_add_f32 v220, v220, v221
    v_mov_b32 v217, v216
    v_mov_b32 v221, v220
    s_nop 0
    v_permlane32_swap_b32 v216, v217
    v_permlane32_swap_b32 v220, v221
    v_max3_f32 v218, v216, v217, v220
    v_rcp_f32 v216, v216
    v_max_f32 v218, v218, v221
    v_rcp_f32 v217, v217
    v_cmp_lt_f32 vcc, 0x67800000, v218
    v_rcp_f32 v220, v220
    v_rcp_f32 v221, v221
    s_cbranch_vccnz L_phiqmax
    v_pk_mul_f32 v[112:113], v[112:113], v[216:217] op_sel:[0,0] op_sel_hi:[1,0]
    v_pk_mul_f32 v[114:115], v[114:115], v[216:217] op_sel:[0,0] op_sel_hi:[1,0]
    v_pk_mul_f32 v[116:117], v[116:117], v[216:217] op_sel:[0,0] op_sel_hi:[1,0]
    v_pk_mul_f32 v[118:119], v[118:119], v[216:217] op_sel:[0,0] op_sel_hi:[1,0]
    v_cvt_pk_bf16_f32 v200, v112, v113
    v_cvt_pk_bf16_f32 v201, v114, v115
    v_cvt_pk_bf16_f32 v202, v116, v117
    v_cvt_pk_bf16_f32 v203, v118, v119
    v_pk_mul_f32 v[120:121], v[120:121], v[216:217] op_sel:[0,1] op_sel_hi:[1,1]
    v_pk_mul_f32 v[122:123], v[122:123], v[216:217] op_sel:[0,1] op_sel_hi:[1,1]
    v_pk_mul_f32 v[124:125], v[124:125], v[216:217] op_sel:[0,1] op_sel_hi:[1,1]
    v_pk_mul_f32 v[126:127], v[126:127], v[216:217] op_sel:[0,1] op_sel_hi:[1,1]
    v_cvt_pk_bf16_f32 v204, v120, v121
    v_cvt_pk_bf16_f32 v205, v122, v123
    v_cvt_pk_bf16_f32 v206, v124, v125
    v_cvt_pk_bf16_f32 v207, v126, v127
    v_pk_mul_f32 v[128:129], v[128:129], v[220:221] op_sel:[0,0] op_sel_hi:[1,0]
    v_pk_mul_f32 v[130:131], v[130:131], v[220:221] op_sel:[0,0] op_sel_hi:[1,0]
    v_pk_mul_f32 v[132:133], v[132:133], v[220:221] op_sel:[0,0] op_sel_hi:[1,0]
    v_pk_mul_f32 v[134:135], v[134:135], v[220:221] op_sel:[0,0] op_sel_hi:[1,0]
    v_cvt_pk_bf16_f32 v208, v128, v129
    v_cvt_pk_bf16_f32 v209, v130, v131
    v_cvt_pk_bf16_f32 v210, v132, v133
    v_cvt_pk_bf16_f32 v211, v134, v135
    v_pk_mul_f32 v[136:137], v[136:137], v[220:221] op_sel:[0,1] op_sel_hi:[1,1]
    v_pk_mul_f32 v[138:139], v[138:139], v[220:221] op_sel:[0,1] op_sel_hi:[1,1]
    v_pk_mul_f32 v[140:141], v[140:141], v[220:221] op_sel:[0,1] op_sel_hi:[1,1]
    v_pk_mul_f32 v[142:143], v[142:143], v[220:221] op_sel:[0,1] op_sel_hi:[1,1]
    v_cvt_pk_bf16_f32 v212, v136, v137
    v_cvt_pk_bf16_f32 v213, v138, v139
    v_cvt_pk_bf16_f32 v214, v140, v141
    v_cvt_pk_bf16_f32 v215, v142, v143
    s_cmp_eq_u32 s33, 3
    s_cselect_b64 s[72:73], 0, -1
    s_cmp_lt_u32 s33, 2
    s_cbranch_scc1 L_stub9
L_stubret9:
    s_mov_b32 s71, 0
L_gsum:
    s_waitcnt vmcnt(8)
    v_add_f32 v228, v224, v225
    v_add_f32 v229, v226, v227
    v_add_f32 v228, v228, v229
    v_mov_b32 v229, v228
    s_nop 1
    v_permlane32_swap_b32 v228, v229
    v_add_f32 v228, v228, v229
    v_mov_b32 v229, v228
    s_nop 1
    v_permlane16_swap_b32 v228, v229
    v_add_f32 v228, v228, v229
    v_cvt_pk_bf16_f32 v229, v228, v228
    ds_write_b16 v79, v229
    s_waitcnt vmcnt(7)
    v_mfma_f32_32x32x16_bf16 v[144:159], v[72:75], v[232:235], 0
    s_waitcnt vmcnt(6)
    v_mfma_f32_32x32x16_bf16 v[144:159], v[72:75], v[236:239], v[144:159]
    s_waitcnt vmcnt(5)
    v_mfma_f32_32x32x16_bf16 v[144:159], v[72:75], v[240:243], v[144:159]
    s_waitcnt vmcnt(4)
    v_mfma_f32_32x32x16_bf16 v[144:159], v[72:75], v[244:247], v[144:159]
    s_waitcnt vmcnt(3)
    v_mfma_f32_32x32x16_bf16 v[144:159], v[72:75], v[168:171], v[144:159]
    s_waitcnt vmcnt(2)
    v_mfma_f32_32x32x16_bf16 v[144:159], v[72:75], v[172:175], v[144:159]
    s_waitcnt vmcnt(1)
    v_mfma_f32_32x32x16_bf16 v[144:159], v[72:75], v[176:179], v[144:159]
    s_waitcnt vmcnt(0)
    v_mfma_f32_32x32x16_bf16 v[144:159], v[72:75], v[180:183], v[144:159]
    s_nop 11
    v_cmp_u_f32 vcc, v144, v228
    v_cvt_pk_bf16_f32 v144, v144, v145
    v_cvt_pk_bf16_f32 v145, v146, v147
    ds_write_b64 v78, v[144:145]
    s_cbranch_vccnz L_gretry
L_gok:
    s_add_u32 s50, s50, 524288
    s_add_u32 s51, s51, 131072
    s_waitcnt lgkmcnt(0)
    s_barrier
    ds_read_b128 v[160:163], v254 offset:0
    ds_read_b128 v[164:167], v254 offset:544
    ds_read_b128 v[168:171], v254 offset:1088
    ds_read_b128 v[172:175], v254 offset:1632
    s_waitcnt lgkmcnt(3)
    v_mfma_f32_32x32x16_bf16 v[112:127], v[160:163], v[200:203], 0
    s_waitcnt lgkmcnt(2)
    v_mfma_f32_32x32x16_bf16 v[112:127], v[164:167], v[204:207], v[112:127]
    s_waitcnt lgkmcnt(1)
    v_mfma_f32_32x32x16_bf16 v[128:143], v[168:171], v[208:211], 0
    s_waitcnt lgkmcnt(0)
    v_mfma_f32_32x32x16_bf16 v[128:143], v[172:175], v[212:215], v[128:143]
    s_nop 7
    v_add_f32 v120, 0x358637bd, v120
    v_rcp_f32 v120, v120
    s_nop 0
    v_mul_f32 v112, v112, v120
    v_mul_f32 v113, v113, v120
    v_mul_f32 v114, v114, v120
    v_mul_f32 v115, v115, v120
    v_mul_f32 v116, v116, v120
    v_mul_f32 v117, v117, v120
    v_mul_f32 v118, v118, v120
    v_mul_f32 v119, v119, v120
    v_cvt_pk_bf16_f32 v240, v112, v113
    v_cvt_pk_bf16_f32 v241, v114, v115
    v_cvt_pk_bf16_f32 v242, v116, v117
    v_cvt_pk_bf16_f32 v243, v118, v119
    v_add_f32 v136, 0x358637bd, v136
    v_rcp_f32 v136, v136
    s_nop 0
    v_pk_mul_f32 v[128:129], v[128:129], v[136:137] op_sel:[0,0] op_sel_hi:[1,0]
    v_pk_mul_f32 v[130:131], v[130:131], v[136:137] op_sel:[0,0] op_sel_hi:[1,0]
    v_pk_mul_f32 v[132:133], v[132:133], v[136:137] op_sel:[0,0] op_sel_hi:[1,0]
    v_pk_mul_f32 v[134:135], v[134:135], v[136:137] op_sel:[0,0] op_sel_hi:[1,0]
    v_cvt_pk_bf16_f32 v244, v128, v129
    v_cvt_pk_bf16_f32 v245, v130, v131
    v_cvt_pk_bf16_f32 v246, v132, v133
    v_cvt_pk_bf16_f32 v247, v134, v135
L_opubB:
    s_cmp_eq_u32 s34, 0
    s_cbranch_scc1 L_opubsB_slow
    buffer_store_dwordx4 v[240:243], v1, s[16:19], s64 offen
    buffer_store_dwordx4 v[244:247], v1, s[16:19], s64 offen offset:1024
    s_mov_b64 exec, s[72:73]
    ds_write_b128 v13, a[208:211] offset:4096
    ds_write_b128 v13, a[212:215] offset:5120
    ds_write_b128 v13, a[216:219] offset:6144
    ds_write_b128 v13, a[220:223] offset:7168
    ds_read_b128 a[192:195], v12 offset:32768
    ds_read_b128 a[196:199], v12 offset:33792
    ds_read_b128 a[200:203], v12 offset:34816
    ds_read_b128 a[204:207], v12 offset:35840
    s_mov_b64 exec, -1
    s_lshr_b32 s63, s30, 1
    s_lshl_b32 s62, s63, 6
    s_add_u32 s69, s24, s35
    s_add_u32 s67, s69, s62
    s_add_u32 s67, s67, 74752
    s_lshl_b32 s63, s63, 14
    s_add_u32 s61, s36, s35
    s_add_u32 s68, s61, s63
    s_add_u32 s68, s68, 32768
    s_mov_b64 exec, 1
    s_waitcnt vmcnt(0)
    buffer_store_dword v96, v111, s[16:19], s65 offen
    buffer_store_dword v96, v111, s[16:19], s65 offen offset:4
    s_mov_b64 exec, -1
L_opubsB_join:
    s_barrier
    buffer_load_dword v249, v110, s[16:19], s67 offen sc1
    s_mov_b32 s39, 0
    s_mov_b64 exec, s[72:73]
    ds_read_b128 a[208:211], v12 offset:36864
    ds_read_b128 a[212:215], v12 offset:37888
    s_mov_b64 exec, -1
    buffer_load_dword v250, v110, s[16:19], s67 offen sc1
    s_mov_b64 exec, s[72:73]
    ds_read_b128 a[216:219], v12 offset:38912
    ds_read_b128 a[220:223], v12 offset:39936
    ds_write_b128 v12, a[160:163] offset:32768
    ds_write_b128 v12, a[164:167] offset:33792
    s_mov_b64 exec, -1
L_poll_12:
    s_waitcnt vmcnt(1)
    v_cmp_ne_u32 vcc, s32, v249
    s_nop 0
    s_cbranch_vccz L_polldone_13
    buffer_load_dword v249, v110, s[16:19], s67 offen sc1
    s_waitcnt vmcnt(1)
    v_cmp_ne_u32 vcc, s32, v250
    s_nop 0
    s_cbranch_vccz L_polldone_13
    buffer_load_dword v250, v110, s[16:19], s67 offen sc1
    s_add_u32 s39, s39, 1
    s_cmp_lt_u32 s39, 1048576
    s_cbranch_scc1 L_poll_12
    s_branch L_end
L_polldone_13:
    buffer_load_dwordx4 a[64:67], v1, s[16:19], s68 offen offset:0 sc1
    buffer_load_dwordx4 a[68:71], v1, s[16:19], s68 offen offset:1024 sc1
    buffer_load_dwordx4 a[72:75], v1, s[16:19], s68 offen offset:2048 sc1
    s_add_u32 s24, s24, 0x80
    s_add_u32 s67, s24, 73728
    s_bfe_u32 s62, s57, 0x60009
    s_add_u32 s62, s62, s69
    s_add_u32 s62, s62, 73856
    v_xor_b32 v8, 0x200, v8
    v_xor_b32 v9, 0x200, v9
    v_xor_b32 v248, 0x2000, v100
    s_mov_b32 s37, 0x3eb8aa3b
    s_mov_b32 s56, 0x3f800000
    buffer_load_dwordx4 a[76:79], v1, s[16:19], s68 offen offset:3072 sc1
    s_add_u32 s66, s68, 4096
    s_mov_b64 exec, s[72:73]
    ds_write_b128 v12, a[168:171] offset:34816
    s_mov_b64 exec, -1
    buffer_load_dwordx4 a[80:83], v1, s[16:19], s66 offen offset:0 sc1
    s_mov_b64 exec, s[72:73]
    ds_write_b128 v12, a[172:175] offset:35840
    s_mov_b64 exec, -1
    buffer_load_dwordx4 a[84:87], v1, s[16:19], s66 offen offset:1024 sc1
    s_mov_b64 exec, s[72:73]
    ds_write_b128 v12, a[176:179] offset:36864
    s_mov_b64 exec, -1
    buffer_load_dwordx4 a[88:91], v1, s[16:19], s66 offen offset:2048 sc1
    s_mov_b64 exec, s[72:73]
    ds_write_b128 v12, a[180:183] offset:37888
    ds_write_b128 v12, a[184:187] offset:38912
    ds_write_b128 v12, a[188:191] offset:39936
    ds_read_b128 a[160:163], v12 offset:0
    ds_read_b128 a[164:167], v12 offset:1024
    ds_read_b128 a[168:171], v12 offset:2048
    ds_read_b128 a[172:175], v12 offset:3072
    ds_read_b128 a[176:179], v12 offset:4096
    ds_read_b128 a[180:183], v12 offset:5120
    ds_read_b128 a[184:187], v12 offset:6144
    ds_read_b128 a[188:191], v12 offset:7168
    s_mov_b64 exec, -1
    s_waitcnt vmcnt(6)
    v_mfma_f32_32x32x16_bf16 v[224:239], a[0:3], a[64:67], 0
    buffer_load_dwordx4 a[92:95], v1, s[16:19], s66 offen offset:3072 sc1
    s_add_u32 s66, s66, 4096
    v_mfma_f32_32x32x16_bf16 v[16:31], a[4:7], a[64:67], v[16:31]
    s_waitcnt vmcnt(6)
    v_mfma_f32_32x32x16_bf16 v[224:239], a[8:11], a[68:71], v[224:239]
    buffer_load_dwordx4 a[96:99], v1, s[16:19], s66 offen offset:0 sc1
    v_mfma_f32_32x32x16_bf16 v[16:31], a[12:15], a[68:71], v[16:31]
    s_waitcnt vmcnt(6)
    v_mfma_f32_32x32x16_bf16 v[224:239], a[16:19], a[72:75], v[224:239]
    buffer_load_dwordx4 a[100:103], v1, s[16:19], s66 offen offset:1024 sc1
    v_mfma_f32_32x32x16_bf16 v[16:31], a[20:23], a[72:75], v[16:31]
    s_waitcnt vmcnt(6)
    v_mfma_f32_32x32x16_bf16 v[224:239], a[24:27], a[76:79], v[224:239]
    buffer_load_dwordx4 a[104:107], v1, s[16:19], s66 offen offset:2048 sc1
    v_mfma_f32_32x32x16_bf16 v[16:31], a[28:31], a[76:79], v[16:31]
    s_waitcnt vmcnt(6)
    v_mfma_f32_32x32x16_bf16 v[224:239], a[32:35], a[80:83], v[224:239]
    buffer_load_dwordx4 a[108:111], v1, s[16:19], s66 offen offset:3072 sc1
    s_add_u32 s66, s66, 4096
    v_mfma_f32_32x32x16_bf16 v[16:31], a[36:39], a[80:83], v[16:31]
    s_waitcnt vmcnt(6)
    v_mfma_f32_32x32x16_bf16 v[224:239], a[40:43], a[84:87], v[224:239]
    buffer_load_dwordx4 a[112:115], v1, s[16:19], s66 offen offset:0 sc1
    v_mfma_f32_32x32x16_bf16 v[16:31], a[44:47], a[84:87], v[16:31]
    s_waitcnt vmcnt(6)
    v_mfma_f32_32x32x16_bf16 v[224:239], a[48:51], a[88:91], v[224:239]
    ds_read_b64_tr_b16 v[176:177], v109 offset:0
    ds_read_b64_tr_b16 v[178:179], v109 offset:1024
    buffer_load_dwordx4 a[116:119], v1, s[16:19], s66 offen offset:1024 sc1
    v_mfma_f32_32x32x16_bf16 v[16:31], a[52:55], a[88:91], v[16:31]
    ds_read_b64_tr_b16 v[180:181], v98 offset:0
    ds_read_b64_tr_b16 v[182:183], v98 offset:1024
    s_waitcnt vmcnt(6)
    v_mfma_f32_32x32x16_bf16 v[224:239], a[56:59], a[92:95], v[224:239]
    ds_read_b64_tr_b16 v[160:161], v109 offset:2048
    ds_read_b64_tr_b16 v[162:163], v109 offset:3072
    buffer_load_dwordx4 a[120:123], v1, s[16:19], s66 offen offset:2048 sc1
    v_mfma_f32_32x32x16_bf16 v[16:31], a[60:63], a[92:95], v[16:31]
    ds_read_b64_tr_b16 v[164:165], v98 offset:2048
    ds_read_b64_tr_b16 v[166:167], v98 offset:3072
    s_waitcnt vmcnt(6) lgkmcnt(6)
    v_mfma_f32_32x32x16_bf16 v[224:239], v[176:179], a[96:99], v[224:239]
    ds_read_b64_tr_b16 v[168:169], v109 offset:4096
    ds_read_b64_tr_b16 v[170:171], v109 offset:5120
    buffer_load_dwordx4 a[124:127], v1, s[16:19], s66 offen offset:3072 sc1
    s_add_u32 s66, s66, 4096
    s_waitcnt lgkmcnt(6)
    v_mfma_f32_32x32x16_bf16 v[16:31], v[180:183], a[96:99], v[16:31]
    ds_read_b64_tr_b16 v[172:173], v98 offset:4096
    ds_read_b64_tr_b16 v[174:175], v98 offset:5120
    s_waitcnt vmcnt(6) lgkmcnt(6)
    v_mfma_f32_32x32x16_bf16 v[224:239], v[160:163], a[100:103], v[224:239]
    ds_read_b64_tr_b16 v[176:177], v109 offset:6144
    ds_read_b64_tr_b16 v[178:179], v109 offset:7168
    s_waitcnt lgkmcnt(6)
    v_mfma_f32_32x32x16_bf16 v[16:31], v[164:167], a[100:103], v[16:31]
    ds_read_b64_tr_b16 v[180:181], v98 offset:6144
    ds_read_b64_tr_b16 v[182:183], v98 offset:7168
    s_waitcnt vmcnt(5) lgkmcnt(6)
    v_mfma_f32_32x32x16_bf16 v[224:239], v[168:171], a[104:107], v[224:239]
    ds_read_b64_tr_b16 v[160:161], v109 offset:8192
    ds_read_b64_tr_b16 v[162:163], v109 offset:9216
    s_waitcnt lgkmcnt(6)
    v_mfma_f32_32x32x16_bf16 v[16:31], v[172:175], a[104:107], v[16:31]
    ds_read_b64_tr_b16 v[164:165], v109 offset:10240
    ds_read_b64_tr_b16 v[166:167], v109 offset:11264
    s_waitcnt vmcnt(4) lgkmcnt(6)
    v_mfma_f32_32x32x16_bf16 v[224:239], v[176:179], a[108:111], v[224:239]
    ds_read_b64_tr_b16 v[168:169], v109 offset:12288
    ds_read_b64_tr_b16 v[170:171], v109 offset:13312
    s_waitcnt lgkmcnt(6)
    v_mfma_f32_32x32x16_bf16 v[16:31], v[180:183], a[108:111], v[16:31]
    ds_read_b64_tr_b16 v[172:173], v109 offset:14336
    ds_read_b64_tr_b16 v[174:175], v109 offset:15360
    s_waitcnt vmcnt(3) lgkmcnt(6)
    v_mfma_f32_32x32x16_bf16 v[224:239], v[160:163], a[112:115], v[224:239]
    ds_read_b64_tr_b16 v[176:177], v98 offset:8192
    ds_read_b64_tr_b16 v[178:179], v98 offset:9216
    s_waitcnt vmcnt(2) lgkmcnt(6)
    v_mfma_f32_32x32x16_bf16 v[224:239], v[164:167], a[116:119], v[224:239]
    ds_read_b64_tr_b16 v[180:181], v98 offset:10240
    ds_read_b64_tr_b16 v[182:183], v98 offset:11264
    s_waitcnt vmcnt(1) lgkmcnt(6)
    v_mfma_f32_32x32x16_bf16 v[224:239], v[168:171], a[120:123], v[224:239]
    ds_read_b64_tr_b16 v[160:161], v98 offset:12288
    ds_read_b64_tr_b16 v[162:163], v98 offset:13312
    s_waitcnt vmcnt(0) lgkmcnt(6)
    v_mfma_f32_32x32x16_bf16 v[224:239], v[172:175], a[124:127], v[224:239]
    ds_read_b64_tr_b16 v[164:165], v98 offset:14336
    ds_read_b64_tr_b16 v[166:167], v98 offset:15360
    s_waitcnt lgkmcnt(6)
    v_mfma_f32_32x32x16_bf16 v[16:31], v[176:179], a[112:115], v[16:31]
    s_waitcnt lgkmcnt(4)
    v_mfma_f32_32x32x16_bf16 v[16:31], v[180:183], a[116:119], v[16:31]
    s_nop 5
    ds_write_b128 v248, v[224:227] offset:0
    ds_write_b128 v248, v[228:231] offset:1024
    s_waitcnt lgkmcnt(4)
    v_mfma_f32_32x32x16_bf16 v[16:31], v[160:163], a[120:123], v[16:31]
    ds_write_b128 v248, v[232:235] offset:2048
    s_waitcnt lgkmcnt(3)
    v_mfma_f32_32x32x16_bf16 v[16:31], v[164:167], a[124:127], v[16:31]
    ds_write_b128 v248, v[236:239] offset:3072
    s_waitcnt lgkmcnt(0)
    s_barrier
    ds_read_b128 v[224:227], v100 offset:0
    ds_read_b128 v[228:231], v100 offset:1024
    ds_read_b128 v[232:235], v100 offset:2048
    ds_read_b128 v[236:239], v100 offset:3072
    s_waitcnt lgkmcnt(3)
    s_nop 3
    v_pk_add_f32 v[16:17], v[16:17], v[224:225]
    v_pk_add_f32 v[18:19], v[18:19], v[226:227]
    v_cvt_pk_bf16_f32 v240, v16, v17
    v_cvt_pk_bf16_f32 v241, v18, v19
    s_waitcnt lgkmcnt(2)
    v_pk_add_f32 v[20:21], v[20:21], v[228:229]
    v_pk_add_f32 v[22:23], v[22:23], v[230:231]
    v_cvt_pk_bf16_f32 v242, v20, v21
    v_cvt_pk_bf16_f32 v243, v22, v23
    s_waitcnt lgkmcnt(1)
    v_pk_add_f32 v[24:25], v[24:25], v[232:233]
    v_pk_add_f32 v[26:27], v[26:27], v[234:235]
    v_cvt_pk_bf16_f32 v244, v24, v25
    v_cvt_pk_bf16_f32 v245, v26, v27
    s_waitcnt lgkmcnt(0)
    v_pk_add_f32 v[28:29], v[28:29], v[236:237]
    v_pk_add_f32 v[30:31], v[30:31], v[238:239]
    v_cvt_pk_bf16_f32 v246, v28, v29
    v_cvt_pk_bf16_f32 v247, v30, v31
    s_cmp_eq_u32 s33, 3
    s_cbranch_scc1 L_final
    s_cmp_eq_u32 s34, 0
    s_cbranch_scc1 L_xpubsB_slow
    buffer_store_dwordx4 v[240:243], v1, s[16:19], s57 offen
    buffer_store_dwordx4 v[244:247], v1, s[16:19], s57 offen offset:1024
    v_pk_add_f32 v[116:117], v[16:17], v[18:19]
    v_pk_mul_f32 v[118:119], v[16:17], v[16:17]
    v_pk_fma_f32 v[118:119], v[18:19], v[18:19], v[118:119]
    v_pk_add_f32 v[116:117], v[116:117], v[20:21]
    v_pk_fma_f32 v[118:119], v[20:21], v[20:21], v[118:119]
    v_pk_add_f32 v[116:117], v[116:117], v[22:23]
    v_pk_fma_f32 v[118:119], v[22:23], v[22:23], v[118:119]
    v_pk_add_f32 v[116:117], v[116:117], v[24:25]
    v_pk_fma_f32 v[118:119], v[24:25], v[24:25], v[118:119]
    v_pk_add_f32 v[116:117], v[116:117], v[26:27]
    v_pk_fma_f32 v[118:119], v[26:27], v[26:27], v[118:119]
    v_pk_add_f32 v[116:117], v[116:117], v[28:29]
    v_pk_fma_f32 v[118:119], v[28:29], v[28:29], v[118:119]
    v_pk_add_f32 v[116:117], v[116:117], v[30:31]
    v_pk_fma_f32 v[118:119], v[30:31], v[30:31], v[118:119]
    v_add_f32 v116, v116, v117
    v_add_f32 v118, v118, v119
    s_nop 1
    v_permlane32_swap_b32 v116, v118
    v_add_f32 v116, v116, v118
    v_and_or_b32 v116, v116, -16, 4
    buffer_store_dword v116, v7, s[16:19], s61 offen
    ds_write_b128 v12, a[128:131] offset:0
    ds_write_b128 v12, a[132:135] offset:1024
    ds_write_b128 v12, a[136:139] offset:2048
    s_mov_b64 exec, 1
    s_waitcnt vmcnt(1)
    buffer_store_dword v96, v111, s[16:19], s62 offen
    s_mov_b64 exec, -1
L_xpubsB_join:
    ds_write_b128 v12, a[140:143] offset:3072
    ds_write_b128 v12, a[144:147] offset:4096
    ds_write_b128 v12, a[148:151] offset:5120
    ds_write_b128 v12, a[152:155] offset:6144
    ds_write_b128 v12, a[156:159] offset:7168
    s_add_u32 s33, s33, 1
    s_branch L_layer
L_final:
    v_lshlrev_b32 v112, 8, v3
    v_lshrrev_b32 v113, 5, v0
    v_lshl_add_u32 v112, v113, 4, v112
    s_lshr_b32 s60, s61, 2
    s_bfe_u32 s61, s57, 0xa0005
    s_add_u32 s60, s60, s61
    v_permlane32_swap_b32 v240, v242
    v_permlane32_swap_b32 v241, v243
    v_permlane32_swap_b32 v244, v246
    v_permlane32_swap_b32 v245, v247
    buffer_store_dwordx4 v[240:243], v112, s[20:23], s60 offen
    buffer_store_dwordx4 v[244:247], v112, s[20:23], s60 offen offset:32
    s_or_b32 s60, s2, s30
    s_cmp_lg_u32 s60, 0
    s_cbranch_scc1 L_fin2
    s_mov_b32 s60, 18350080
    s_mov_b64 exec, 1
    buffer_store_dword v96, v111, s[16:19], s60 offen
    s_mov_b64 exec, -1
L_fin2:
L_end:
    s_endpgm
L_stretry:
    s_mov_b32 s39, 0
L_stlp:
    buffer_load_dwordx4 v[184:187], v6, s[16:19], s36 offen offset:0 sc1
    buffer_load_dwordx4 v[188:191], v6, s[16:19], s36 offen offset:512 sc1
    buffer_load_dwordx4 v[192:195], v6, s[16:19], s36 offen offset:1024 sc1
    buffer_load_dwordx4 v[196:199], v6, s[16:19], s36 offen offset:1536 sc1
    s_add_u32 s39, s39, 1
    s_cmp_ge_u32 s39, 1048576
    s_cbranch_scc1 L_end
    s_waitcnt vmcnt(0)
    v_bitop3_b32 v250, v184, v185, v186 bitop3:0x80
    v_bitop3_b32 v250, v250, v187, v188 bitop3:0x80
    v_bitop3_b32 v250, v250, v189, v190 bitop3:0x80
    v_bitop3_b32 v250, v250, v191, v192 bitop3:0x80
    v_bitop3_b32 v250, v250, v193, v194 bitop3:0x80
    v_bitop3_b32 v250, v250, v195, v196 bitop3:0x80
    v_bitop3_b32 v250, v250, v197, v198 bitop3:0x80
    v_bitop3_b32 v250, v250, v199, s63 bitop3:0x80
    v_cmp_eq_u32 vcc, 0, v250
    s_nop 3
    s_cbranch_vccnz L_stlp
    s_branch L_stok
L_stub0:
    v_lshlrev_b32 v255, 7, v0
    v_lshrrev_b32 v254, 3, v0
    v_lshl_add_u32 v254, v254, 11, v255
    s_lshl_b32 s60, s70, 12
    s_mul_i32 s62, s70, 12288
    s_mov_b32 exec_hi, 0
    buffer_load_dword v99, v254, s[4:7], s62 offen offset:2048
    s_mov_b64 exec, -1
    s_branch L_stubret0
L_stub1:
    s_waitcnt vmcnt(6)
    v_mov_b32 v254, -1
    v_mov_b32 v255, -1
    s_add_u32 s62, s48, 524288
    s_add_u32 s63, s49, 131072
    buffer_store_dwordx2 v[254:255], v97, s[16:19], s48 offen sc1
    buffer_store_dwordx2 v[254:255], v97, s[16:19], s62 offen sc1
    s_mov_b64 exec, 0xffff
    buffer_store_dword v254, v110, s[16:19], s49 offen sc1
    buffer_store_dword v254, v110, s[16:19], s63 offen sc1
    s_mov_b64 exec, -1
    s_branch L_stubret1
L_stub2:
    v_lshrrev_b32 v240, 2, v0
    v_mul_u32_u24 v240, 3072, v240
    v_and_b32 v241, 0x30, v1
    s_lshl_b32 s60, s29, 6
    v_add3_u32 v240, v240, v241, s60
    s_mul_i32 s61, s30, 393216
    buffer_load_dwordx4 a[224:227], v240, s[8:11], s61 offen offset:2048
    s_add_u32 s61, s61, 49152
    buffer_load_dwordx4 a[228:231], v240, s[8:11], s61 offen offset:2048
    s_add_u32 s61, s61, 49152
    buffer_load_dwordx4 a[232:235], v240, s[8:11], s61 offen offset:2048
    s_add_u32 s61, s61, 49152
    buffer_load_dwordx4 a[236:239], v240, s[8:11], s61 offen offset:2048
    s_add_u32 s61, s61, 49152
    buffer_load_dwordx4 a[240:243], v240, s[8:11], s61 offen offset:2048
    s_add_u32 s61, s61, 49152
    buffer_load_dwordx4 a[244:247], v240, s[8:11], s61 offen offset:2048
    s_add_u32 s61, s61, 49152
    buffer_load_dwordx4 a[248:251], v240, s[8:11], s61 offen offset:2048
    s_add_u32 s61, s61, 49152
    buffer_load_dwordx4 a[252:255], v240, s[8:11], s61 offen offset:2048
    s_branch L_stubret2
L_hretry:
    s_add_u32 s71, s71, 1
    s_cmp_ge_u32 s71, 524288
    s_cbranch_scc1 L_end
    s_mov_b32 s39, 0
    s_cmp_lt_u32 s71, 3
    s_cbranch_scc1 L_hgo
L_hpl:
    buffer_load_dword v237, v249, s[16:19], s43 offen sc1
    buffer_load_dword v239, v249, s[16:19], s69 offen sc1
    s_add_u32 s39, s39, 1
    s_waitcnt vmcnt(0)
    v_cmp_ne_u32 vcc, v236, v237
    v_cmp_ne_u32 s[60:61], v238, v239
    s_cmp_ge_u32 s39, 4
    s_cselect_b64 s[62:63], -1, 0
    s_or_b64 vcc, vcc, s[60:61]
    s_or_b64 vcc, vcc, s[62:63]
    s_cbranch_scc0 L_hpl
L_hgo:
    v_cmp_lt_u32 vcc, 1, v250
    s_nop 3
    s_cbranch_vccz L_hsk_14
    buffer_load_dwordx4 v[204:207], v1, s[16:19], s42 offen offset:0 sc1
    buffer_load_dwordx4 v[208:211], v1, s[16:19], s42 offen offset:1024 sc1
    buffer_load_dwordx4 v[212:215], v1, s[16:19], s42 offen offset:2048 sc1
    buffer_load_dwordx4 v[216:219], v1, s[16:19], s42 offen offset:3072 sc1
    buffer_load_dword v236, v249, s[16:19], s43 offen sc1
L_hsk_14:
    v_cmp_lt_u32 vcc, 1, v251
    s_nop 3
    s_cbranch_vccz L_hsk_15
    buffer_load_dwordx4 v[220:223], v1, s[16:19], s68 offen offset:0 sc1
    buffer_load_dwordx4 v[224:227], v1, s[16:19], s68 offen offset:1024 sc1
    buffer_load_dwordx4 v[228:231], v1, s[16:19], s68 offen offset:2048 sc1
    buffer_load_dwordx4 v[232:235], v1, s[16:19], s68 offen offset:3072 sc1
    buffer_load_dword v238, v249, s[16:19], s69 offen sc1
L_hsk_15:
    s_waitcnt vmcnt(0)
    s_branch L_hcheck
L_virt:
    s_waitcnt vmcnt(0)
    v_mov_b32 v204, 0
    v_mov_b32 v205, 0
    v_mov_b32 v206, 0
    v_mov_b32 v207, 0
    ds_write_b128 v253, v[204:207] offset:0
    ds_write_b128 v253, v[204:207] offset:1024
    ds_write_b128 v253, v[204:207] offset:2048
    ds_write_b128 v253, v[204:207] offset:3088
    ds_write_b128 v253, v[204:207] offset:4128
    ds_write_b128 v253, v[204:207] offset:5152
    ds_write_b128 v253, v[204:207] offset:6176
    ds_write_b128 v253, v[204:207] offset:7216
    s_mov_b64 exec, 3
    ds_write_b128 v254, v[204:207] offset:3072
    ds_write_b128 v254, v[204:207] offset:7200
    s_mov_b64 exec, -1
    ds_write_b32 v102, v111 offset:16
    s_branch L_hj
L_stub3:
    s_lshl_b32 s60, s28, 13
    s_add_u32 s60, s60, s54
    s_mov_b64 exec, 1
    buffer_store_dword v96, v111, s[16:19], s60 offen sc1
    s_mov_b64 exec, -1
    v_lshlrev_b32 v241, 10, v0
    s_mul_i32 s60, s70, 12288
    s_mov_b64 exec, 0x6db
    buffer_load_dword v99, v241, s[4:7], s60 offen offset:384
    s_mov_b64 exec, -1
    s_mov_b32 s6, 0
    s_bfe_u32 s67, s2, 0x20003
    s_add_u32 s61, s67, 0
    s_and_b32 s61, s61, 3
    s_lshl2_add_u32 s61, s30, s61
    s_lshl_b32 m0, s61, 11
    s_mul_i32 s61, s61, 98304
    s_add_u32 s60, s61, 48128
    buffer_load_dwordx4 v240, s[8:11], s61 offen lds
    buffer_load_dwordx4 v240, s[8:11], s60 offen offset:1024 lds
    s_add_u32 m0, m0, 31744
    s_nop 0
    buffer_load_dwordx4 v240, s[8:11], s61 offen offset:1024 lds
    buffer_load_dwordx4 v240, s[8:11], s60 offen offset:2048 lds
    s_getpc_b64 s[60:61]
L_pc_16:
    s_sub_u32 s60, s60, L_pc_16-interleave_layers__sliding_block__linear_kernel_hedgehog__prompt_kernel
    s_subb_u32 s61, s61, 0
    s_lshl_b32 s62, s70, 8
    v_lshl_add_u32 v241, v0, 7, s62
    s_mov_b64 exec, 3
    global_load_dword v99, v241, s[60:61]
    s_mov_b64 exec, -1
    v_lshlrev_b32 v241, 7, v0
    s_add_u32 s60, s36, s55
    s_add_u32 s60, s60, 32768
    s_mov_b64 exec, 0xffff
    buffer_load_dword v99, v241, s[16:19], s60 offen
    s_mov_b64 exec, -1
    s_branch L_stubret3
L_stub4:
    s_add_u32 s61, s67, 1
    s_and_b32 s61, s61, 3
    s_lshl2_add_u32 s61, s30, s61
    s_lshl_b32 m0, s61, 11
    s_mul_i32 s61, s61, 98304
    s_add_u32 s60, s61, 48128
    buffer_load_dwordx4 v240, s[8:11], s61 offen lds
    buffer_load_dwordx4 v240, s[8:11], s60 offen offset:1024 lds
    s_add_u32 m0, m0, 31744
    s_nop 0
    buffer_load_dwordx4 v240, s[8:11], s61 offen offset:1024 lds
    buffer_load_dwordx4 v240, s[8:11], s60 offen offset:2048 lds
    s_branch L_stubret4
L_stub5:
    s_add_u32 s61, s67, 2
    s_and_b32 s61, s61, 3
    s_lshl2_add_u32 s61, s30, s61
    s_lshl_b32 m0, s61, 11
    s_mul_i32 s61, s61, 98304
    s_add_u32 s60, s61, 48128
    buffer_load_dwordx4 v240, s[8:11], s61 offen lds
    buffer_load_dwordx4 v240, s[8:11], s60 offen offset:1024 lds
    s_add_u32 m0, m0, 31744
    s_nop 0
    buffer_load_dwordx4 v240, s[8:11], s61 offen offset:1024 lds
    buffer_load_dwordx4 v240, s[8:11], s60 offen offset:2048 lds
    s_branch L_stubret5
L_stub6:
    s_add_u32 s61, s67, 3
    s_and_b32 s61, s61, 3
    s_lshl2_add_u32 s61, s30, s61
    s_lshl_b32 m0, s61, 11
    s_mul_i32 s61, s61, 98304
    s_add_u32 s60, s61, 48128
    buffer_load_dwordx4 v240, s[8:11], s61 offen lds
    buffer_load_dwordx4 v240, s[8:11], s60 offen offset:1024 lds
    s_add_u32 m0, m0, 31744
    s_nop 0
    buffer_load_dwordx4 v240, s[8:11], s61 offen offset:1024 lds
    buffer_load_dwordx4 v240, s[8:11], s60 offen offset:2048 lds
    s_branch L_stubret6
L_opubsA2_slow:
    buffer_store_dwordx4 v[240:243], v1, s[16:19], s46 offen sc1
    buffer_store_dwordx4 v[244:247], v1, s[16:19], s47 offen  sc1
    ds_write_b128 v12, a[192:195] offset:32768
    ds_write_b128 v12, a[196:199] offset:33792
    ds_write_b128 v12, a[200:203] offset:34816
    ds_write_b128 v12, a[204:207] offset:35840
    ds_write_b128 v12, a[208:211] offset:36864
    ds_write_b128 v12, a[212:215] offset:37888
    s_lshr_b32 s63, s30, 1
    s_lshl_b32 s62, s63, 6
    s_add_u32 s69, s24, s35
    s_add_u32 s67, s69, s62
    s_add_u32 s67, s67, 74752
    s_lshl_b32 s63, s63, 14
    s_add_u32 s61, s36, s35
    s_add_u32 s68, s61, s63
    s_add_u32 s68, s68, 32768
    s_mov_b64 exec, 1
    s_waitcnt vmcnt(0)
    buffer_store_dword v96, v111, s[16:19], s38 offen sc1
    buffer_store_dword v96, v111, s[16:19], s25 offen  sc1
    s_mov_b64 exec, -1
    s_branch L_opubsA2_join
L_xpubsA2_slow:
    buffer_store_dwordx4 v[240:243], v1, s[16:19], s57 offen sc1
    buffer_store_dwordx4 v[244:247], v1, s[16:19], s57 offen offset:1024 sc1
    v_pk_add_f32 v[116:117], v[16:17], v[18:19]
    v_pk_mul_f32 v[118:119], v[16:17], v[16:17]
    v_pk_fma_f32 v[118:119], v[18:19], v[18:19], v[118:119]
    v_pk_add_f32 v[116:117], v[116:117], v[20:21]
    v_pk_fma_f32 v[118:119], v[20:21], v[20:21], v[118:119]
    v_pk_add_f32 v[116:117], v[116:117], v[22:23]
    v_pk_fma_f32 v[118:119], v[22:23], v[22:23], v[118:119]
    v_pk_add_f32 v[116:117], v[116:117], v[24:25]
    v_pk_fma_f32 v[118:119], v[24:25], v[24:25], v[118:119]
    v_pk_add_f32 v[116:117], v[116:117], v[26:27]
    v_pk_fma_f32 v[118:119], v[26:27], v[26:27], v[118:119]
    v_pk_add_f32 v[116:117], v[116:117], v[28:29]
    v_pk_fma_f32 v[118:119], v[28:29], v[28:29], v[118:119]
    v_pk_add_f32 v[116:117], v[116:117], v[30:31]
    v_pk_fma_f32 v[118:119], v[30:31], v[30:31], v[118:119]
    v_add_f32 v116, v116, v117
    v_add_f32 v118, v118, v119
    s_nop 1
    v_permlane32_swap_b32 v116, v118
    v_add_f32 v116, v116, v118
    v_and_or_b32 v116, v116, -16, 8
    buffer_store_dword v116, v7, s[16:19], s61 offen sc1
    ds_write_b128 v12, a[160:163] offset:0
    ds_write_b128 v12, a[164:167] offset:1024
    ds_write_b128 v12, a[168:171] offset:2048
    s_mov_b64 exec, 1
    s_waitcnt vmcnt(0)
    buffer_store_dword v96, v111, s[16:19], s62 offen sc1
    s_mov_b64 exec, -1
    s_branch L_xpubsA2_join
L_opubsA0_slow:
    buffer_store_dwordx4 v[240:243], v1, s[16:19], s46 offen sc1
    buffer_store_dwordx4 v[244:247], v1, s[16:19], s47 offen  sc1
    s_lshl_b32 s63, s30, 13
    s_sub_u32 s63, s63, 131072
    v_add_u32 v220, s63, v4
    v_add_u32 v221, 0x10000, v220
    v_lshrrev_b32 v216, 4, v0
    v_xor_b32 v216, v216, v0
    v_and_b32 v216, 1, v216
    v_add_u32 v216, -1, v216
    v_and_b32 v216, 0x3f803f80, v216
    v_mov_b32 v217, v216
    v_mov_b32 v218, v216
    v_mov_b32 v219, v216
    s_waitcnt vmcnt(2)
    ds_read_b64_tr_b16 v[184:185], v220 offset:32768
    ds_read_b64_tr_b16 v[186:187], v220 offset:33280
    ds_read_b64_tr_b16 v[188:189], v220 offset:33792
    ds_read_b64_tr_b16 v[190:191], v220 offset:34304
    ds_read_b64_tr_b16 v[192:193], v220 offset:34816
    ds_read_b64_tr_b16 v[194:195], v220 offset:35328
    s_waitcnt lgkmcnt(4)
    v_mfma_f32_16x16x32_bf16 v[112:115], v[216:219], v[184:187], 0
    ds_write_b128 v12, v[184:187] offset:32768
    ds_read_b64_tr_b16 v[196:197], v220 offset:35840
    ds_read_b64_tr_b16 v[198:199], v220 offset:36352
    s_waitcnt lgkmcnt(5)
    v_mfma_f32_16x16x32_bf16 v[112:115], v[216:219], v[188:191], v[112:115]
    ds_write_b128 v12, v[188:191] offset:33792
    s_lshr_b32 s63, s30, 1
    s_lshl_b32 s62, s63, 6
    s_add_u32 s69, s24, s35
    s_add_u32 s67, s69, s62
    s_add_u32 s67, s67, 74752
    s_lshl_b32 s63, s63, 14
    s_add_u32 s61, s36, s35
    s_add_u32 s68, s61, s63
    s_add_u32 s68, s68, 32768
    s_mov_b64 exec, 1
    s_waitcnt vmcnt(0)
    buffer_store_dword v96, v111, s[16:19], s38 offen sc1
    buffer_store_dword v96, v111, s[16:19], s25 offen  sc1
    s_mov_b64 exec, -1
    s_branch L_opubsA0_join
L_xpubsA0_slow:
    buffer_store_dwordx4 v[240:243], v1, s[16:19], s57 offen sc1
    buffer_store_dwordx4 v[244:247], v1, s[16:19], s57 offen offset:1024 sc1
    v_pk_add_f32 v[116:117], v[16:17], v[18:19]
    v_pk_mul_f32 v[118:119], v[16:17], v[16:17]
    v_pk_fma_f32 v[118:119], v[18:19], v[18:19], v[118:119]
    v_pk_add_f32 v[116:117], v[116:117], v[20:21]
    v_pk_fma_f32 v[118:119], v[20:21], v[20:21], v[118:119]
    v_pk_add_f32 v[116:117], v[116:117], v[22:23]
    v_pk_fma_f32 v[118:119], v[22:23], v[22:23], v[118:119]
    v_pk_add_f32 v[116:117], v[116:117], v[24:25]
    v_pk_fma_f32 v[118:119], v[24:25], v[24:25], v[118:119]
    v_pk_add_f32 v[116:117], v[116:117], v[26:27]
    v_pk_fma_f32 v[118:119], v[26:27], v[26:27], v[118:119]
    v_pk_add_f32 v[116:117], v[116:117], v[28:29]
    v_pk_fma_f32 v[118:119], v[28:29], v[28:29], v[118:119]
    v_pk_add_f32 v[116:117], v[116:117], v[30:31]
    v_pk_fma_f32 v[118:119], v[30:31], v[30:31], v[118:119]
    v_add_f32 v116, v116, v117
    v_add_f32 v118, v118, v119
    s_nop 1
    v_permlane32_swap_b32 v116, v118
    v_add_f32 v116, v116, v118
    v_and_or_b32 v116, v116, -16, 2
    buffer_store_dword v116, v7, s[16:19], s61 offen sc1
    ds_write_b128 v12, v[184:187] offset:0
    ds_write_b128 v12, v[188:191] offset:1024
    ds_write_b128 v12, v[192:195] offset:2048
    s_mov_b64 exec, 1
    s_waitcnt vmcnt(0)
    buffer_store_dword v96, v111, s[16:19], s62 offen sc1
    s_mov_b64 exec, -1
    s_branch L_xpubsA0_join
L_stub7:
    v_lshlrev_b32 v255, 7, v0
    s_lshl_b32 s60, s70, 12
    s_mov_b32 exec_hi, 0
    buffer_load_dword v99, v255, s[12:15], s60 offen
    s_mov_b64 exec, -1
    s_branch L_stubret7
L_phikmax:
    s_nop 1
    v_mfma_f32_32x32x16_bf16 v[144:159], v[64:67], v[168:171], 0
    v_mfma_f32_32x32x16_bf16 v[112:127], v[68:71], v[172:175], 0
    s_nop 10
    v_max3_f32 v128, v144, v145, v146
    v_max3_f32 v128, v128, v147, v148
    v_max3_f32 v128, v128, v149, v150
    v_max_f32 v128, v128, v151
    v_max3_f32 v129, v152, v153, v154
    v_max3_f32 v129, v129, v155, v156
    v_max3_f32 v129, v129, v157, v158
    v_max_f32 v129, v129, v159
    s_nop 1
    v_permlane32_swap_b32 v128, v129
    v_max_f32 v128, v128, v129
    v_mov_b32 v129, v128
    s_nop 1
    v_permlane32_swap_b32 v128, v129
    v_sub_f32 v144, v144, v128
    v_sub_f32 v145, v145, v128
    v_sub_f32 v146, v146, v128
    v_sub_f32 v147, v147, v128
    v_sub_f32 v148, v148, v128
    v_sub_f32 v149, v149, v128
    v_sub_f32 v150, v150, v128
    v_sub_f32 v151, v151, v128
    v_sub_f32 v152, v152, v129
    v_sub_f32 v153, v153, v129
    v_sub_f32 v154, v154, v129
    v_sub_f32 v155, v155, v129
    v_sub_f32 v156, v156, v129
    v_sub_f32 v157, v157, v129
    v_sub_f32 v158, v158, v129
    v_sub_f32 v159, v159, v129
    v_max3_f32 v132, v112, v113, v114
    v_max3_f32 v132, v132, v115, v116
    v_max3_f32 v132, v132, v117, v118
    v_max_f32 v132, v132, v119
    v_max3_f32 v133, v120, v121, v122
    v_max3_f32 v133, v133, v123, v124
    v_max3_f32 v133, v133, v125, v126
    v_max_f32 v133, v133, v127
    s_nop 1
    v_permlane32_swap_b32 v132, v133
    v_max_f32 v132, v132, v133
    v_mov_b32 v133, v132
    s_nop 1
    v_permlane32_swap_b32 v132, v133
    v_sub_f32 v112, v112, v132
    v_sub_f32 v113, v113, v132
    v_sub_f32 v114, v114, v132
    v_sub_f32 v115, v115, v132
    v_sub_f32 v116, v116, v132
    v_sub_f32 v117, v117, v132
    v_sub_f32 v118, v118, v132
    v_sub_f32 v119, v119, v132
    v_sub_f32 v120, v120, v133
    v_sub_f32 v121, v121, v133
    v_sub_f32 v122, v122, v133
    v_sub_f32 v123, v123, v133
    v_sub_f32 v124, v124, v133
    v_sub_f32 v125, v125, v133
    v_sub_f32 v126, v126, v133
    v_sub_f32 v127, v127, v133
    s_nop 0
    s_branch L_phikret
L_stub8:
    s_waitcnt vmcnt(2)
    s_branch L_stubret8
L_sfwait:
    s_waitcnt vmcnt(0)
    v_lshlrev_b32 v255, 11, v110
    s_mov_b32 s39, 0
L_poll_17:
    buffer_load_dword v248, v255, s[16:19], s54 offen offset:0 sc1
    s_add_u32 s39, s39, 1
    s_cmp_ge_u32 s39, 1048576
    s_cbranch_scc1 L_end
    s_waitcnt vmcnt(0)
    v_cmp_ne_u32 vcc, s32, v248
    s_nop 0
    s_cbranch_vccnz L_poll_17
    s_nop 1
    s_branch L_sfok
L_phiqmax:
    s_nop 1
    v_mfma_f32_32x32x16_bf16 v[112:127], v[64:67], v[160:163], 0
    v_mfma_f32_32x32x16_bf16 v[128:143], v[68:71], v[164:167], 0
    s_nop 10
    v_max3_f32 v216, v112, v113, v114
    v_max3_f32 v216, v216, v115, v116
    v_max3_f32 v216, v216, v117, v118
    v_max_f32 v216, v216, v119
    v_max3_f32 v217, v120, v121, v122
    v_max3_f32 v217, v217, v123, v124
    v_max3_f32 v217, v217, v125, v126
    v_max_f32 v217, v217, v127
    s_nop 1
    v_permlane32_swap_b32 v216, v217
    v_max_f32 v216, v216, v217
    v_mov_b32 v217, v216
    s_nop 1
    v_permlane32_swap_b32 v216, v217
    v_sub_f32 v112, v112, v216
    v_sub_f32 v113, v113, v216
    v_sub_f32 v114, v114, v216
    v_sub_f32 v115, v115, v216
    v_sub_f32 v116, v116, v216
    v_sub_f32 v117, v117, v216
    v_sub_f32 v118, v118, v216
    v_sub_f32 v119, v119, v216
    v_sub_f32 v120, v120, v217
    v_sub_f32 v121, v121, v217
    v_sub_f32 v122, v122, v217
    v_sub_f32 v123, v123, v217
    v_sub_f32 v124, v124, v217
    v_sub_f32 v125, v125, v217
    v_sub_f32 v126, v126, v217
    v_sub_f32 v127, v127, v217
    v_max3_f32 v220, v128, v129, v130
    v_max3_f32 v220, v220, v131, v132
    v_max3_f32 v220, v220, v133, v134
    v_max_f32 v220, v220, v135
    v_max3_f32 v221, v136, v137, v138
    v_max3_f32 v221, v221, v139, v140
    v_max3_f32 v221, v221, v141, v142
    v_max_f32 v221, v221, v143
    s_nop 1
    v_permlane32_swap_b32 v220, v221
    v_max_f32 v220, v220, v221
    v_mov_b32 v221, v220
    s_nop 1
    v_permlane32_swap_b32 v220, v221
    v_sub_f32 v128, v128, v220
    v_sub_f32 v129, v129, v220
    v_sub_f32 v130, v130, v220
    v_sub_f32 v131, v131, v220
    v_sub_f32 v132, v132, v220
    v_sub_f32 v133, v133, v220
    v_sub_f32 v134, v134, v220
    v_sub_f32 v135, v135, v220
    v_sub_f32 v136, v136, v221
    v_sub_f32 v137, v137, v221
    v_sub_f32 v138, v138, v221
    v_sub_f32 v139, v139, v221
    v_sub_f32 v140, v140, v221
    v_sub_f32 v141, v141, v221
    v_sub_f32 v142, v142, v221
    v_sub_f32 v143, v143, v221
    s_nop 0
    s_branch L_phiqret
L_stub9:
    ds_read_b128 a[224:227], v13 offset:0
    ds_read_b128 a[228:231], v13 offset:1024
    ds_read_b128 a[232:235], v13 offset:2048
    ds_read_b128 a[236:239], v13 offset:3072
    ds_read_b128 a[240:243], v13 offset:4096
    ds_read_b128 a[244:247], v13 offset:5120
    ds_read_b128 a[248:251], v13 offset:6144
    ds_read_b128 a[252:255], v13 offset:7168
    ds_write_b128 v13, a[192:195] offset:0
    ds_write_b128 v13, a[196:199] offset:1024
    ds_write_b128 v13, a[200:203] offset:2048
    ds_write_b128 v13, a[204:207] offset:3072
    s_branch L_stubret9
L_gretry:
    v_max3_u32 v228, v224, v225, v226
    v_max_u32 v228, v228, v227
    v_cmp_eq_u32 s[62:63], -1, v228
    buffer_load_dword v224, v249, s[16:19], s51 offen offset:0 sc1
    buffer_load_dword v225, v249, s[16:19], s51 offen offset:512 sc1
    buffer_load_dword v226, v249, s[16:19], s51 offen offset:1024 sc1
    buffer_load_dword v227, v249, s[16:19], s51 offen offset:1536 sc1
    v_max_u32 v228, v232, v234
    v_cmp_eq_u32 vcc, -1, v228
    s_nop 3
    s_cbranch_vccz L_gsk_20
    buffer_load_dwordx4 v[232:235], v1, s[16:19], s50 offen offset:0 sc1
    s_mov_b64 s[62:63], -1
L_gsk_20:
    v_max_u32 v228, v236, v238
    v_cmp_eq_u32 vcc, -1, v228
    s_nop 3
    s_cbranch_vccz L_gsk_21
    buffer_load_dwordx4 v[236:239], v1, s[16:19], s50 offen offset:1024 sc1
    s_mov_b64 s[62:63], -1
L_gsk_21:
    v_max_u32 v228, v240, v242
    v_cmp_eq_u32 vcc, -1, v228
    s_nop 3
    s_cbranch_vccz L_gsk_22
    buffer_load_dwordx4 v[240:243], v1, s[16:19], s50 offen offset:2048 sc1
    s_mov_b64 s[62:63], -1
L_gsk_22:
    v_max_u32 v228, v244, v246
    v_cmp_eq_u32 vcc, -1, v228
    s_nop 3
    s_cbranch_vccz L_gsk_23
    buffer_load_dwordx4 v[244:247], v1, s[16:19], s50 offen offset:3072 sc1
    s_mov_b64 s[62:63], -1
L_gsk_23:
    v_max_u32 v228, v168, v170
    v_cmp_eq_u32 vcc, -1, v228
    s_nop 3
    s_cbranch_vccz L_gsk_24
    buffer_load_dwordx4 v[168:171], v1, s[16:19], s67 offen offset:0 sc1
    s_mov_b64 s[62:63], -1
L_gsk_24:
    v_max_u32 v228, v172, v174
    v_cmp_eq_u32 vcc, -1, v228
    s_nop 3
    s_cbranch_vccz L_gsk_25
    buffer_load_dwordx4 v[172:175], v1, s[16:19], s67 offen offset:1024 sc1
    s_mov_b64 s[62:63], -1
L_gsk_25:
    v_max_u32 v228, v176, v178
    v_cmp_eq_u32 vcc, -1, v228
    s_nop 3
    s_cbranch_vccz L_gsk_26
    buffer_load_dwordx4 v[176:179], v1, s[16:19], s67 offen offset:2048 sc1
    s_mov_b64 s[62:63], -1
L_gsk_26:
    v_max_u32 v228, v180, v182
    v_cmp_eq_u32 vcc, -1, v228
    s_nop 3
    s_cbranch_vccz L_gsk_27
    buffer_load_dwordx4 v[180:183], v1, s[16:19], s67 offen offset:3072 sc1
    s_mov_b64 s[62:63], -1
L_gsk_27:
    s_waitcnt vmcnt(0)
    s_cmp_lg_u64 s[62:63], 0
    s_cselect_b32 s60, 1, 1024
    s_add_u32 s71, s71, s60
    s_cmp_ge_u32 s71, 0x10000
    s_cbranch_scc1 L_gok
    s_cmp_eq_u32 s60, 1
    s_cbranch_scc1 L_gsum
    buffer_load_dwordx4 v[232:235], v1, s[16:19], s50 offen offset:0 sc1
    buffer_load_dwordx4 v[236:239], v1, s[16:19], s50 offen offset:1024 sc1
    buffer_load_dwordx4 v[240:243], v1, s[16:19], s50 offen offset:2048 sc1
    buffer_load_dwordx4 v[244:247], v1, s[16:19], s50 offen offset:3072 sc1
    buffer_load_dwordx4 v[168:171], v1, s[16:19], s67 offen offset:0 sc1
    buffer_load_dwordx4 v[172:175], v1, s[16:19], s67 offen offset:1024 sc1
    buffer_load_dwordx4 v[176:179], v1, s[16:19], s67 offen offset:2048 sc1
    buffer_load_dwordx4 v[180:183], v1, s[16:19], s67 offen offset:3072 sc1
    s_waitcnt vmcnt(0)
    s_branch L_gsum
L_opubsB_slow:
    buffer_store_dwordx4 v[240:243], v1, s[16:19], s64 offen sc1
    buffer_store_dwordx4 v[244:247], v1, s[16:19], s64 offen offset:1024 sc1
    s_mov_b64 exec, s[72:73]
    ds_write_b128 v13, a[208:211] offset:4096
    ds_write_b128 v13, a[212:215] offset:5120
    ds_write_b128 v13, a[216:219] offset:6144
    ds_write_b128 v13, a[220:223] offset:7168
    ds_read_b128 a[192:195], v12 offset:32768
    ds_read_b128 a[196:199], v12 offset:33792
    ds_read_b128 a[200:203], v12 offset:34816
    ds_read_b128 a[204:207], v12 offset:35840
    s_mov_b64 exec, -1
    s_lshr_b32 s63, s30, 1
    s_lshl_b32 s62, s63, 6
    s_add_u32 s69, s24, s35
    s_add_u32 s67, s69, s62
    s_add_u32 s67, s67, 74752
    s_lshl_b32 s63, s63, 14
    s_add_u32 s61, s36, s35
    s_add_u32 s68, s61, s63
    s_add_u32 s68, s68, 32768
    s_mov_b64 exec, 1
    s_waitcnt vmcnt(0)
    buffer_store_dword v96, v111, s[16:19], s65 offen sc1
    buffer_store_dword v96, v111, s[16:19], s65 offen offset:4 sc1
    s_mov_b64 exec, -1
    s_branch L_opubsB_join
L_xpubsB_slow:
    buffer_store_dwordx4 v[240:243], v1, s[16:19], s57 offen sc1
    buffer_store_dwordx4 v[244:247], v1, s[16:19], s57 offen offset:1024 sc1
    v_pk_add_f32 v[116:117], v[16:17], v[18:19]
    v_pk_mul_f32 v[118:119], v[16:17], v[16:17]
    v_pk_fma_f32 v[118:119], v[18:19], v[18:19], v[118:119]
    v_pk_add_f32 v[116:117], v[116:117], v[20:21]
    v_pk_fma_f32 v[118:119], v[20:21], v[20:21], v[118:119]
    v_pk_add_f32 v[116:117], v[116:117], v[22:23]
    v_pk_fma_f32 v[118:119], v[22:23], v[22:23], v[118:119]
    v_pk_add_f32 v[116:117], v[116:117], v[24:25]
    v_pk_fma_f32 v[118:119], v[24:25], v[24:25], v[118:119]
    v_pk_add_f32 v[116:117], v[116:117], v[26:27]
    v_pk_fma_f32 v[118:119], v[26:27], v[26:27], v[118:119]
    v_pk_add_f32 v[116:117], v[116:117], v[28:29]
    v_pk_fma_f32 v[118:119], v[28:29], v[28:29], v[118:119]
    v_pk_add_f32 v[116:117], v[116:117], v[30:31]
    v_pk_fma_f32 v[118:119], v[30:31], v[30:31], v[118:119]
    v_add_f32 v116, v116, v117
    v_add_f32 v118, v118, v119
    s_nop 1
    v_permlane32_swap_b32 v116, v118
    v_add_f32 v116, v116, v118
    v_and_or_b32 v116, v116, -16, 4
    buffer_store_dword v116, v7, s[16:19], s61 offen sc1
    ds_write_b128 v12, a[128:131] offset:0
    ds_write_b128 v12, a[132:135] offset:1024
    ds_write_b128 v12, a[136:139] offset:2048
    s_mov_b64 exec, 1
    s_waitcnt vmcnt(0)
    buffer_store_dword v96, v111, s[16:19], s62 offen sc1
    s_mov_b64 exec, -1
    s_branch L_xpubsB_join
L_fallback:
    s_waitcnt lgkmcnt(0)
    s_nop 15
    s_cmp_lg_u32 s33, 0
    s_cbranch_scc1 L_fbskip_28
    s_add_u32 s61, s67, 1
    s_and_b32 s61, s61, 3
    s_lshl2_add_u32 s61, s30, s61
    s_lshl_b32 m0, s61, 11
    s_mul_i32 s61, s61, 98304
    s_add_u32 s60, s61, 48128
    buffer_load_dwordx4 v240, s[8:11], s61 offen lds
    buffer_load_dwordx4 v240, s[8:11], s60 offen offset:1024 lds
    s_add_u32 m0, m0, 31744
    s_nop 0
    buffer_load_dwordx4 v240, s[8:11], s61 offen offset:1024 lds
    buffer_load_dwordx4 v240, s[8:11], s60 offen offset:2048 lds
    s_add_u32 s61, s67, 2
    s_and_b32 s61, s61, 3
    s_lshl2_add_u32 s61, s30, s61
    s_lshl_b32 m0, s61, 11
    s_mul_i32 s61, s61, 98304
    s_add_u32 s60, s61, 48128
    buffer_load_dwordx4 v240, s[8:11], s61 offen lds
    buffer_load_dwordx4 v240, s[8:11], s60 offen offset:1024 lds
    s_add_u32 m0, m0, 31744
    s_nop 0
    buffer_load_dwordx4 v240, s[8:11], s61 offen offset:1024 lds
    buffer_load_dwordx4 v240, s[8:11], s60 offen offset:2048 lds
    s_add_u32 s61, s67, 3
    s_and_b32 s61, s61, 3
    s_lshl2_add_u32 s61, s30, s61
    s_lshl_b32 m0, s61, 11
    s_mul_i32 s61, s61, 98304
    s_add_u32 s60, s61, 48128
    buffer_load_dwordx4 v240, s[8:11], s61 offen lds
    buffer_load_dwordx4 v240, s[8:11], s60 offen offset:1024 lds
    s_add_u32 m0, m0, 31744
    s_nop 0
    buffer_load_dwordx4 v240, s[8:11], s61 offen offset:1024 lds
    buffer_load_dwordx4 v240, s[8:11], s60 offen offset:2048 lds
L_fbskip_28:
    s_add_u32 m0, s66, 131072
    s_mov_b32 s62, 131072
    buffer_load_dwordx4 v5, s[12:15], s62 offen lds
    s_mov_b32 s62, 138240
    buffer_load_dwordx4 v5, s[12:15], s62 offen offset:1024 lds
    s_add_u32 m0, s66, 133120
    s_mov_b32 s62, 147456
    buffer_load_dwordx4 v5, s[12:15], s62 offen lds
    s_mov_b32 s62, 154624
    buffer_load_dwordx4 v5, s[12:15], s62 offen offset:1024 lds
    s_add_u32 m0, s66, 135168
    s_mov_b32 s62, 163840
    buffer_load_dwordx4 v5, s[12:15], s62 offen lds
    s_mov_b32 s62, 171008
    buffer_load_dwordx4 v5, s[12:15], s62 offen offset:1024 lds
    s_add_u32 m0, s66, 137216
    s_mov_b32 s62, 180224
    buffer_load_dwordx4 v5, s[12:15], s62 offen lds
    s_mov_b32 s62, 187392
    buffer_load_dwordx4 v5, s[12:15], s62 offen offset:1024 lds
    s_and_b32 s71, s30, 1
    s_lshr_b32 s62, s30, 1
    s_lshl_b32 s60, s71, 1
    s_add_u32 s60, s60, s62
    s_lshl_b32 s60, s60, 10
    s_add_u32 s60, s60, 115072
    v_add_u32 v203, s60, v1
    ds_read_b128 v[112:115], v203
    s_lshl_b32 s60, s28, 2
    s_add_u32 s60, s60, s71
    s_min_u32 s66, s60, 7
    s_cmp_ge_u32 s60, 8
    s_cselect_b32 s67, 1, 0
    s_mul_i32 s60, s71, 4128
    s_add_u32 s60, s60, 98560
    s_lshl_b32 s61, s62, 10
    s_add_u32 s69, s61, s60
    v_add_u32 v200, s69, v1
    s_lshl_b32 s61, s62, 8
    s_add_u32 s61, s61, s60
    s_add_u32 s61, s61, 2048
    v_add_u32 v201, s61, v1
    v_mov_b32 v120, 0x3f803f80
    v_mov_b32 v121, 0x3f803f80
    v_mov_b32 v122, 0x3f803f80
    v_mov_b32 v123, 0x3f803f80
    v_mov_b32 v124, 0x3f803f80
    v_mov_b32 v125, 0x3f803f80
    v_mov_b32 v126, 0x3f803f80
    v_mov_b32 v127, 0x3f803f80
    v_mov_b32 v204, v201
    ds_read_b128 v[116:119], v200
    s_waitcnt lgkmcnt(0)
    v_mfma_f32_32x32x16_bf16 v[128:143], v[116:119], v[112:115], v[32:47]
    s_nop 11
    v_max_f32 v202, v128, v129
    v_max3_f32 v202, v202, v130, v131
    v_max3_f32 v202, v202, v132, v133
    v_max3_f32 v202, v202, v134, v135
    v_max3_f32 v202, v202, v136, v137
    v_max3_f32 v202, v202, v138, v139
    v_max3_f32 v202, v202, v140, v141
    v_max3_f32 v202, v202, v142, v143
    s_mov_b32 s68, s66
    s_nop 0
L_lp_29:
    s_cmp_eq_u32 s68, 0
    s_cbranch_scc1 L_done_30
    v_add_u32 v200, 4294963168, v200
    v_add_u32 v201, 4294963168, v201
    ds_read_b128 v[116:119], v200
    s_waitcnt lgkmcnt(0)
    v_mfma_f32_32x32x16_bf16 v[128:143], v[116:119], v[112:115], 0
    s_nop 11
    v_max3_f32 v202, v202, v128, v129
    v_max3_f32 v202, v202, v130, v131
    v_max3_f32 v202, v202, v132, v133
    v_max3_f32 v202, v202, v134, v135
    v_max3_f32 v202, v202, v136, v137
    v_max3_f32 v202, v202, v138, v139
    v_max3_f32 v202, v202, v140, v141
    v_max3_f32 v202, v202, v142, v143
    s_sub_u32 s68, s68, 1
    s_branch L_lp_29
L_done_30:
    s_cmp_eq_u32 s67, 0
    s_cbranch_scc1 L_nofar_31
    v_add_u32 v200, 4294963168, v200
    v_add_u32 v201, 4294963168, v201
    ds_read_b128 v[116:119], v200
    s_waitcnt lgkmcnt(0)
    v_mfma_f32_32x32x16_bf16 v[128:143], v[116:119], v[112:115], v[48:63]
    s_nop 11
    v_max3_f32 v202, v202, v128, v129
    v_max3_f32 v202, v202, v130, v131
    v_max3_f32 v202, v202, v132, v133
    v_max3_f32 v202, v202, v134, v135
    v_max3_f32 v202, v202, v136, v137
    v_max3_f32 v202, v202, v138, v139
    v_max3_f32 v202, v202, v140, v141
    v_max3_f32 v202, v202, v142, v143
    s_nop 1
L_nofar_31:
    v_mov_b32 v203, v202
    s_nop 1
    v_permlane32_swap_b32 v202, v203
    v_max_f32 v202, v202, v203
    v_add_u32 v200, s69, v1
    v_mov_b32 v201, v204
    v_sub_f32 v168, 0, v202
    v_sub_f32 v184, v32, v202
    v_sub_f32 v169, 0, v202
    v_sub_f32 v185, v33, v202
    v_sub_f32 v170, 0, v202
    v_sub_f32 v186, v34, v202
    v_sub_f32 v171, 0, v202
    v_sub_f32 v187, v35, v202
    v_sub_f32 v172, 0, v202
    v_sub_f32 v188, v36, v202
    v_sub_f32 v173, 0, v202
    v_sub_f32 v189, v37, v202
    v_sub_f32 v174, 0, v202
    v_sub_f32 v190, v38, v202
    v_sub_f32 v175, 0, v202
    v_sub_f32 v191, v39, v202
    v_sub_f32 v176, 0, v202
    v_sub_f32 v192, v40, v202
    v_sub_f32 v177, 0, v202
    v_sub_f32 v193, v41, v202
    v_sub_f32 v178, 0, v202
    v_sub_f32 v194, v42, v202
    v_sub_f32 v179, 0, v202
    v_sub_f32 v195, v43, v202
    v_sub_f32 v180, 0, v202
    v_sub_f32 v196, v44, v202
    v_sub_f32 v181, 0, v202
    v_sub_f32 v197, v45, v202
    v_sub_f32 v182, 0, v202
    v_sub_f32 v198, v46, v202
    v_sub_f32 v183, 0, v202
    v_sub_f32 v199, v47, v202
    ds_read_b128 v[116:119], v200
    s_mov_b64 exec, s[58:59]
    ds_read_b128 v[120:123], v201
    ds_read_b128 v[124:127], v201 offset:1040
    s_mov_b64 exec, -1
    s_waitcnt lgkmcnt(2)
    v_mfma_f32_32x32x16_bf16 v[128:143], v[116:119], v[112:115], v[184:199]
    s_nop 11
    v_exp_f32 v128, v128
    v_exp_f32 v129, v129
    v_exp_f32 v130, v130
    v_exp_f32 v131, v131
    v_exp_f32 v132, v132
    v_exp_f32 v133, v133
    v_exp_f32 v134, v134
    v_exp_f32 v135, v135
    v_exp_f32 v136, v136
    v_exp_f32 v137, v137
    v_exp_f32 v138, v138
    v_exp_f32 v139, v139
    v_exp_f32 v140, v140
    v_exp_f32 v141, v141
    v_exp_f32 v142, v142
    v_exp_f32 v143, v143
    v_cvt_pk_bf16_f32 v144, v128, v129
    v_cvt_pk_bf16_f32 v145, v130, v131
    v_cvt_pk_bf16_f32 v146, v132, v133
    v_cvt_pk_bf16_f32 v147, v134, v135
    v_cvt_pk_bf16_f32 v148, v136, v137
    v_cvt_pk_bf16_f32 v149, v138, v139
    v_cvt_pk_bf16_f32 v150, v140, v141
    v_cvt_pk_bf16_f32 v151, v142, v143
    s_waitcnt lgkmcnt(1)
    v_mfma_f32_32x32x16_bf16 v[152:167], v[120:123], v[144:147], 0
    s_waitcnt lgkmcnt(0)
    v_mfma_f32_32x32x16_bf16 v[152:167], v[124:127], v[148:151], v[152:167]
    s_mov_b32 s68, s66
    s_nop 10
L_lp_32:
    s_cmp_eq_u32 s68, 0
    s_cbranch_scc1 L_done_33
    v_add_u32 v200, 4294963168, v200
    v_add_u32 v201, 4294963168, v201
    ds_read_b128 v[116:119], v200
    s_mov_b64 exec, s[58:59]
    ds_read_b128 v[120:123], v201
    ds_read_b128 v[124:127], v201 offset:1040
    s_mov_b64 exec, -1
    s_waitcnt lgkmcnt(2)
    v_mfma_f32_32x32x16_bf16 v[128:143], v[116:119], v[112:115], v[168:183]
    s_nop 11
    v_exp_f32 v128, v128
    v_exp_f32 v129, v129
    v_exp_f32 v130, v130
    v_exp_f32 v131, v131
    v_exp_f32 v132, v132
    v_exp_f32 v133, v133
    v_exp_f32 v134, v134
    v_exp_f32 v135, v135
    v_exp_f32 v136, v136
    v_exp_f32 v137, v137
    v_exp_f32 v138, v138
    v_exp_f32 v139, v139
    v_exp_f32 v140, v140
    v_exp_f32 v141, v141
    v_exp_f32 v142, v142
    v_exp_f32 v143, v143
    v_cvt_pk_bf16_f32 v144, v128, v129
    v_cvt_pk_bf16_f32 v145, v130, v131
    v_cvt_pk_bf16_f32 v146, v132, v133
    v_cvt_pk_bf16_f32 v147, v134, v135
    v_cvt_pk_bf16_f32 v148, v136, v137
    v_cvt_pk_bf16_f32 v149, v138, v139
    v_cvt_pk_bf16_f32 v150, v140, v141
    v_cvt_pk_bf16_f32 v151, v142, v143
    s_waitcnt lgkmcnt(1)
    v_mfma_f32_32x32x16_bf16 v[152:167], v[120:123], v[144:147], v[152:167]
    s_waitcnt lgkmcnt(0)
    v_mfma_f32_32x32x16_bf16 v[152:167], v[124:127], v[148:151], v[152:167]
    s_sub_u32 s68, s68, 1
    s_nop 9
    s_branch L_lp_32
L_done_33:
    s_cmp_eq_u32 s67, 0
    s_cbranch_scc1 L_nofar_34
    v_add_u32 v200, 4294963168, v200
    v_add_u32 v201, 4294963168, v201
    v_sub_f32 v184, v48, v202
    v_sub_f32 v185, v49, v202
    v_sub_f32 v186, v50, v202
    v_sub_f32 v187, v51, v202
    v_sub_f32 v188, v52, v202
    v_sub_f32 v189, v53, v202
    v_sub_f32 v190, v54, v202
    v_sub_f32 v191, v55, v202
    v_sub_f32 v192, v56, v202
    v_sub_f32 v193, v57, v202
    v_sub_f32 v194, v58, v202
    v_sub_f32 v195, v59, v202
    v_sub_f32 v196, v60, v202
    v_sub_f32 v197, v61, v202
    v_sub_f32 v198, v62, v202
    v_sub_f32 v199, v63, v202
    ds_read_b128 v[116:119], v200
    s_mov_b64 exec, s[58:59]
    ds_read_b128 v[120:123], v201
    ds_read_b128 v[124:127], v201 offset:1040
    s_mov_b64 exec, -1
    s_waitcnt lgkmcnt(2)
    v_mfma_f32_32x32x16_bf16 v[128:143], v[116:119], v[112:115], v[184:199]
    s_nop 11
    v_exp_f32 v128, v128
    v_exp_f32 v129, v129
    v_exp_f32 v130, v130
    v_exp_f32 v131, v131
    v_exp_f32 v132, v132
    v_exp_f32 v133, v133
    v_exp_f32 v134, v134
    v_exp_f32 v135, v135
    v_exp_f32 v136, v136
    v_exp_f32 v137, v137
    v_exp_f32 v138, v138
    v_exp_f32 v139, v139
    v_exp_f32 v140, v140
    v_exp_f32 v141, v141
    v_exp_f32 v142, v142
    v_exp_f32 v143, v143
    v_cvt_pk_bf16_f32 v144, v128, v129
    v_cvt_pk_bf16_f32 v145, v130, v131
    v_cvt_pk_bf16_f32 v146, v132, v133
    v_cvt_pk_bf16_f32 v147, v134, v135
    v_cvt_pk_bf16_f32 v148, v136, v137
    v_cvt_pk_bf16_f32 v149, v138, v139
    v_cvt_pk_bf16_f32 v150, v140, v141
    v_cvt_pk_bf16_f32 v151, v142, v143
    s_waitcnt lgkmcnt(1)
    v_mfma_f32_32x32x16_bf16 v[152:167], v[120:123], v[144:147], v[152:167]
    s_waitcnt lgkmcnt(0)
    v_mfma_f32_32x32x16_bf16 v[152:167], v[124:127], v[148:151], v[152:167]
    s_nop 11
L_nofar_34:
    v_rcp_f32 v160, v160
    s_nop 0
    v_pk_mul_f32 v[152:153], v[152:153], v[160:161] op_sel:[0,0] op_sel_hi:[1,0]
    v_pk_mul_f32 v[154:155], v[154:155], v[160:161] op_sel:[0,0] op_sel_hi:[1,0]
    v_pk_mul_f32 v[156:157], v[156:157], v[160:161] op_sel:[0,0] op_sel_hi:[1,0]
    v_pk_mul_f32 v[158:159], v[158:159], v[160:161] op_sel:[0,0] op_sel_hi:[1,0]
    v_cvt_pk_bf16_f32 v240, v152, v153
    v_cvt_pk_bf16_f32 v241, v154, v155
    v_cvt_pk_bf16_f32 v242, v156, v157
    v_cvt_pk_bf16_f32 v243, v158, v159
    s_sub_u32 s71, 3, s71
    s_lshr_b32 s62, s30, 1
    s_lshl_b32 s60, s71, 1
    s_add_u32 s60, s60, s62
    s_lshl_b32 s60, s60, 10
    s_add_u32 s60, s60, 115072
    v_add_u32 v203, s60, v1
    ds_read_b128 v[112:115], v203
    s_lshl_b32 s60, s28, 2
    s_add_u32 s60, s60, s71
    s_min_u32 s66, s60, 7
    s_cmp_ge_u32 s60, 8
    s_cselect_b32 s67, 1, 0
    s_mul_i32 s60, s71, 4128
    s_add_u32 s60, s60, 98560
    s_lshl_b32 s61, s62, 10
    s_add_u32 s69, s61, s60
    v_add_u32 v200, s69, v1
    s_lshl_b32 s61, s62, 8
    s_add_u32 s61, s61, s60
    s_add_u32 s61, s61, 2048
    v_add_u32 v201, s61, v1
    v_mov_b32 v120, 0x3f803f80
    v_mov_b32 v121, 0x3f803f80
    v_mov_b32 v122, 0x3f803f80
    v_mov_b32 v123, 0x3f803f80
    v_mov_b32 v124, 0x3f803f80
    v_mov_b32 v125, 0x3f803f80
    v_mov_b32 v126, 0x3f803f80
    v_mov_b32 v127, 0x3f803f80
    v_mov_b32 v204, v201
    ds_read_b128 v[116:119], v200
    s_waitcnt lgkmcnt(0)
    v_mfma_f32_32x32x16_bf16 v[128:143], v[116:119], v[112:115], v[32:47]
    s_nop 11
    v_max_f32 v202, v128, v129
    v_max3_f32 v202, v202, v130, v131
    v_max3_f32 v202, v202, v132, v133
    v_max3_f32 v202, v202, v134, v135
    v_max3_f32 v202, v202, v136, v137
    v_max3_f32 v202, v202, v138, v139
    v_max3_f32 v202, v202, v140, v141
    v_max3_f32 v202, v202, v142, v143
    s_mov_b32 s68, s66
    s_nop 0
L_lp_35:
    s_cmp_eq_u32 s68, 0
    s_cbranch_scc1 L_done_36
    v_add_u32 v200, 4294963168, v200
    v_add_u32 v201, 4294963168, v201
    ds_read_b128 v[116:119], v200
    s_waitcnt lgkmcnt(0)
    v_mfma_f32_32x32x16_bf16 v[128:143], v[116:119], v[112:115], 0
    s_nop 11
    v_max3_f32 v202, v202, v128, v129
    v_max3_f32 v202, v202, v130, v131
    v_max3_f32 v202, v202, v132, v133
    v_max3_f32 v202, v202, v134, v135
    v_max3_f32 v202, v202, v136, v137
    v_max3_f32 v202, v202, v138, v139
    v_max3_f32 v202, v202, v140, v141
    v_max3_f32 v202, v202, v142, v143
    s_sub_u32 s68, s68, 1
    s_branch L_lp_35
L_done_36:
    s_cmp_eq_u32 s67, 0
    s_cbranch_scc1 L_nofar_37
    v_add_u32 v200, 4294963168, v200
    v_add_u32 v201, 4294963168, v201
    ds_read_b128 v[116:119], v200
    s_waitcnt lgkmcnt(0)
    v_mfma_f32_32x32x16_bf16 v[128:143], v[116:119], v[112:115], v[48:63]
    s_nop 11
    v_max3_f32 v202, v202, v128, v129
    v_max3_f32 v202, v202, v130, v131
    v_max3_f32 v202, v202, v132, v133
    v_max3_f32 v202, v202, v134, v135
    v_max3_f32 v202, v202, v136, v137
    v_max3_f32 v202, v202, v138, v139
    v_max3_f32 v202, v202, v140, v141
    v_max3_f32 v202, v202, v142, v143
    s_nop 1
L_nofar_37:
    v_mov_b32 v203, v202
    s_nop 1
    v_permlane32_swap_b32 v202, v203
    v_max_f32 v202, v202, v203
    v_add_u32 v200, s69, v1
    v_mov_b32 v201, v204
    v_sub_f32 v168, 0, v202
    v_sub_f32 v184, v32, v202
    v_sub_f32 v169, 0, v202
    v_sub_f32 v185, v33, v202
    v_sub_f32 v170, 0, v202
    v_sub_f32 v186, v34, v202
    v_sub_f32 v171, 0, v202
    v_sub_f32 v187, v35, v202
    v_sub_f32 v172, 0, v202
    v_sub_f32 v188, v36, v202
    v_sub_f32 v173, 0, v202
    v_sub_f32 v189, v37, v202
    v_sub_f32 v174, 0, v202
    v_sub_f32 v190, v38, v202
    v_sub_f32 v175, 0, v202
    v_sub_f32 v191, v39, v202
    v_sub_f32 v176, 0, v202
    v_sub_f32 v192, v40, v202
    v_sub_f32 v177, 0, v202
    v_sub_f32 v193, v41, v202
    v_sub_f32 v178, 0, v202
    v_sub_f32 v194, v42, v202
    v_sub_f32 v179, 0, v202
    v_sub_f32 v195, v43, v202
    v_sub_f32 v180, 0, v202
    v_sub_f32 v196, v44, v202
    v_sub_f32 v181, 0, v202
    v_sub_f32 v197, v45, v202
    v_sub_f32 v182, 0, v202
    v_sub_f32 v198, v46, v202
    v_sub_f32 v183, 0, v202
    v_sub_f32 v199, v47, v202
    ds_read_b128 v[116:119], v200
    s_mov_b64 exec, s[58:59]
    ds_read_b128 v[120:123], v201
    ds_read_b128 v[124:127], v201 offset:1040
    s_mov_b64 exec, -1
    s_waitcnt lgkmcnt(2)
    v_mfma_f32_32x32x16_bf16 v[128:143], v[116:119], v[112:115], v[184:199]
    s_nop 11
    v_exp_f32 v128, v128
    v_exp_f32 v129, v129
    v_exp_f32 v130, v130
    v_exp_f32 v131, v131
    v_exp_f32 v132, v132
    v_exp_f32 v133, v133
    v_exp_f32 v134, v134
    v_exp_f32 v135, v135
    v_exp_f32 v136, v136
    v_exp_f32 v137, v137
    v_exp_f32 v138, v138
    v_exp_f32 v139, v139
    v_exp_f32 v140, v140
    v_exp_f32 v141, v141
    v_exp_f32 v142, v142
    v_exp_f32 v143, v143
    v_cvt_pk_bf16_f32 v144, v128, v129
    v_cvt_pk_bf16_f32 v145, v130, v131
    v_cvt_pk_bf16_f32 v146, v132, v133
    v_cvt_pk_bf16_f32 v147, v134, v135
    v_cvt_pk_bf16_f32 v148, v136, v137
    v_cvt_pk_bf16_f32 v149, v138, v139
    v_cvt_pk_bf16_f32 v150, v140, v141
    v_cvt_pk_bf16_f32 v151, v142, v143
    s_waitcnt lgkmcnt(1)
    v_mfma_f32_32x32x16_bf16 v[152:167], v[120:123], v[144:147], 0
    s_waitcnt lgkmcnt(0)
    v_mfma_f32_32x32x16_bf16 v[152:167], v[124:127], v[148:151], v[152:167]
    s_mov_b32 s68, s66
    s_nop 10
L_lp_38:
    s_cmp_eq_u32 s68, 0
    s_cbranch_scc1 L_done_39
    v_add_u32 v200, 4294963168, v200
    v_add_u32 v201, 4294963168, v201
    ds_read_b128 v[116:119], v200
    s_mov_b64 exec, s[58:59]
    ds_read_b128 v[120:123], v201
    ds_read_b128 v[124:127], v201 offset:1040
    s_mov_b64 exec, -1
    s_waitcnt lgkmcnt(2)
    v_mfma_f32_32x32x16_bf16 v[128:143], v[116:119], v[112:115], v[168:183]
    s_nop 11
    v_exp_f32 v128, v128
    v_exp_f32 v129, v129
    v_exp_f32 v130, v130
    v_exp_f32 v131, v131
    v_exp_f32 v132, v132
    v_exp_f32 v133, v133
    v_exp_f32 v134, v134
    v_exp_f32 v135, v135
    v_exp_f32 v136, v136
    v_exp_f32 v137, v137
    v_exp_f32 v138, v138
    v_exp_f32 v139, v139
    v_exp_f32 v140, v140
    v_exp_f32 v141, v141
    v_exp_f32 v142, v142
    v_exp_f32 v143, v143
    v_cvt_pk_bf16_f32 v144, v128, v129
    v_cvt_pk_bf16_f32 v145, v130, v131
    v_cvt_pk_bf16_f32 v146, v132, v133
    v_cvt_pk_bf16_f32 v147, v134, v135
    v_cvt_pk_bf16_f32 v148, v136, v137
    v_cvt_pk_bf16_f32 v149, v138, v139
    v_cvt_pk_bf16_f32 v150, v140, v141
    v_cvt_pk_bf16_f32 v151, v142, v143
    s_waitcnt lgkmcnt(1)
    v_mfma_f32_32x32x16_bf16 v[152:167], v[120:123], v[144:147], v[152:167]
    s_waitcnt lgkmcnt(0)
    v_mfma_f32_32x32x16_bf16 v[152:167], v[124:127], v[148:151], v[152:167]
    s_sub_u32 s68, s68, 1
    s_nop 9
    s_branch L_lp_38
L_done_39:
    s_cmp_eq_u32 s67, 0
    s_cbranch_scc1 L_nofar_40
    v_add_u32 v200, 4294963168, v200
    v_add_u32 v201, 4294963168, v201
    v_sub_f32 v184, v48, v202
    v_sub_f32 v185, v49, v202
    v_sub_f32 v186, v50, v202
    v_sub_f32 v187, v51, v202
    v_sub_f32 v188, v52, v202
    v_sub_f32 v189, v53, v202
    v_sub_f32 v190, v54, v202
    v_sub_f32 v191, v55, v202
    v_sub_f32 v192, v56, v202
    v_sub_f32 v193, v57, v202
    v_sub_f32 v194, v58, v202
    v_sub_f32 v195, v59, v202
    v_sub_f32 v196, v60, v202
    v_sub_f32 v197, v61, v202
    v_sub_f32 v198, v62, v202
    v_sub_f32 v199, v63, v202
    ds_read_b128 v[116:119], v200
    s_mov_b64 exec, s[58:59]
    ds_read_b128 v[120:123], v201
    ds_read_b128 v[124:127], v201 offset:1040
    s_mov_b64 exec, -1
    s_waitcnt lgkmcnt(2)
    v_mfma_f32_32x32x16_bf16 v[128:143], v[116:119], v[112:115], v[184:199]
    s_nop 11
    v_exp_f32 v128, v128
    v_exp_f32 v129, v129
    v_exp_f32 v130, v130
    v_exp_f32 v131, v131
    v_exp_f32 v132, v132
    v_exp_f32 v133, v133
    v_exp_f32 v134, v134
    v_exp_f32 v135, v135
    v_exp_f32 v136, v136
    v_exp_f32 v137, v137
    v_exp_f32 v138, v138
    v_exp_f32 v139, v139
    v_exp_f32 v140, v140
    v_exp_f32 v141, v141
    v_exp_f32 v142, v142
    v_exp_f32 v143, v143
    v_cvt_pk_bf16_f32 v144, v128, v129
    v_cvt_pk_bf16_f32 v145, v130, v131
    v_cvt_pk_bf16_f32 v146, v132, v133
    v_cvt_pk_bf16_f32 v147, v134, v135
    v_cvt_pk_bf16_f32 v148, v136, v137
    v_cvt_pk_bf16_f32 v149, v138, v139
    v_cvt_pk_bf16_f32 v150, v140, v141
    v_cvt_pk_bf16_f32 v151, v142, v143
    s_waitcnt lgkmcnt(1)
    v_mfma_f32_32x32x16_bf16 v[152:167], v[120:123], v[144:147], v[152:167]
    s_waitcnt lgkmcnt(0)
    v_mfma_f32_32x32x16_bf16 v[152:167], v[124:127], v[148:151], v[152:167]
    s_nop 11
L_nofar_40:
    v_rcp_f32 v160, v160
    s_nop 0
    v_pk_mul_f32 v[152:153], v[152:153], v[160:161] op_sel:[0,0] op_sel_hi:[1,0]
    v_pk_mul_f32 v[154:155], v[154:155], v[160:161] op_sel:[0,0] op_sel_hi:[1,0]
    v_pk_mul_f32 v[156:157], v[156:157], v[160:161] op_sel:[0,0] op_sel_hi:[1,0]
    v_pk_mul_f32 v[158:159], v[158:159], v[160:161] op_sel:[0,0] op_sel_hi:[1,0]
    v_cvt_pk_bf16_f32 v244, v152, v153
    v_cvt_pk_bf16_f32 v245, v154, v155
    v_cvt_pk_bf16_f32 v246, v156, v157
    v_cvt_pk_bf16_f32 v247, v158, v159
    s_nop 0
    s_branch L_opubA
    .fill 4096, 4, 0xbf810000
.section .rodata,"a"
.p2align 6
.amdhsa_kernel interleave_layers__sliding_block__linear_kernel_hedgehog__prompt_kernel
  .amdhsa_next_free_vgpr 512
  .amdhsa_next_free_sgpr 102
  .amdhsa_accum_offset 256
  .amdhsa_group_segment_fixed_size 0
  .amdhsa_kernarg_size 80
  .amdhsa_user_sgpr_count 2
  .amdhsa_user_sgpr_kernarg_segment_ptr 1
  .amdhsa_system_sgpr_workgroup_id_x 1
.end_amdhsa_kernel
```
